```python
import torch

def _softmax(x, axis=-1):
    return torch.softmax(x, dim=axis)
def _gelu(x):
    return torch.nn.functional.gelu(x, approximate="tanh")
def _silu(x):
    return torch.nn.functional.silu(x)
def _sigmoid(x):
    return torch.sigmoid(x)
def _layernorm(x, axis=-1, eps=1e-5):
    m = x.mean(dim=axis, keepdim=True)
    v = x.var(dim=axis, keepdim=True, unbiased=False)
    return (x - m) / torch.sqrt(v + eps)
def _scatter_add(tgt, idx, src, axis=0):
    return tgt.clone().index_add_(axis, idx, src)
def _segment_sum(src, seg, n):
    out = torch.zeros((n,) + src.shape[1:], dtype=src.dtype)
    return out.index_add_(0, seg, src)
def _pad(x, pw):
    flat = tuple(v for pair in reversed(pw) for v in pair)
    return torch.nn.functional.pad(x, flat)

kernel_name = 'sequential_preLN__compressed_kv_cla__dense_activation_silu__decode'

def setup_inputs():

    _w = (lambda a: (lambda t: t.to(torch.bfloat16) if t.is_floating_point() else t)(torch.as_tensor(a)))
    def _A_setup():
        B, H, Sq, Sk, D, M = 1, 32, 1, 8192, 128, 576
        Dc = 4 * D
        return {
            "x": _w((lambda *s: torch.randn(*s, dtype=torch.bfloat16) * 0.05)(B, Sq, M)),
            "c_kv": _w((lambda *s: torch.randn(*s, dtype=torch.bfloat16) * 0.8)(B, Sk, Dc)),
            "w_q": _w((lambda *s: torch.randn(*s, dtype=torch.bfloat16) * 3.2)(M, H, D) * (M ** -0.5)),
            "w_uk": _w((lambda *s: torch.randn(*s, dtype=torch.bfloat16) * 3.2)(Dc, H, D) * (Dc ** -0.5)),
            "w_uv": _w((lambda *s: torch.randn(*s, dtype=torch.bfloat16) * 0.8)(Dc, H, D) * (Dc ** -0.5)),
            "w_o": _w((lambda *s: torch.randn(*s, dtype=torch.bfloat16) * 0.8)(H, D, M) * ((H * D) ** -0.5)),
        }
    _A_in = _A_setup()

    def _B_setup():
        B, S, D, F = 1, 1, 576, 4608
        return {
            "x": _w((lambda *s: torch.randn(*s, dtype=torch.bfloat16) * 0.05)(B, S, D)),
            "w1": _w((lambda *s: torch.randn(*s, dtype=torch.bfloat16) * 3.2)(D, F) * (D ** -0.5)),
            "w2": _w((lambda *s: torch.randn(*s, dtype=torch.bfloat16) * 0.2)(F, D) * (F ** -0.5)),
        }
    _B_in = _B_setup()

    return {
        "A_x": _A_in["x"],
        "A_c_kv": _A_in["c_kv"],
        "A_w_q": _A_in["w_q"],
        "A_w_uk": _A_in["w_uk"],
        "A_w_uv": _A_in["w_uv"],
        "A_w_o": _A_in["w_o"],
        "B_x": _B_in["x"],
        "B_w1": _B_in["w1"],
        "B_w2": _B_in["w2"],
    }

def reference(A_x, A_c_kv, A_w_q, A_w_uk, A_w_uv, A_w_o, B_x, B_w1, B_w2):
    def _A_ref(x, c_kv, w_q, w_uk, w_uv, w_o):
        B, Sq, M = x.shape[0], x.shape[1], x.shape[2]
        Sk = c_kv.shape[1]
        H, D = w_q.shape[1], w_q.shape[2]
        q = torch.einsum("bqm,mhd->bhqd", x, w_q)
        k = torch.einsum("bkc,chd->bhkd", c_kv, w_uk)
        v = torch.einsum("bkc,chd->bhkd", c_kv, w_uv)
        scores = torch.einsum("bhqd,bhkd->bhqk", q, k) * (D ** -0.5)
        off = Sk - Sq
        qi = torch.arange(Sq)[:, None]
        kj = torch.arange(Sk)[None, :]
        cmask = kj <= (qi + off)
        scores = torch.where(cmask[None, None], scores, -1e9)
        p = _softmax(scores, axis=-1)
        ctx = torch.einsum("bhqk,bhkd->bhqd", p, v)
        return torch.einsum("bhqd,hdm->bqm", ctx, w_o)

    def _B_ref(x, w1, w2):
        h = torch.einsum("bsd,df->bsf", x, w1)
        h = _silu(h)
        out = torch.einsum("bsf,fd->bsd", h, w2)
        return out

    x = A_x
    h = x + _A_ref(_layernorm(x, axis=-1), A_c_kv, A_w_q, A_w_uk, A_w_uv, A_w_o)
    h2 = h + _B_ref(_layernorm(h, axis=-1), B_w1, B_w2)
    return h2
```

```asm
; @launch grid=(256,1,1) block=(512,1,1) lds=154880
.amdgcn_target "amdgcn-amd-amdhsa--gfx950"
.text
.globl sequential_preLN__compressed_kv_cla__dense_activation_silu__decode_kernel
.p2align 12
.p2align 8
.type sequential_preLN__compressed_kv_cla__dense_activation_silu__decode_kernel,@function
sequential_preLN__compressed_kv_cla__dense_activation_silu__decode_kernel:
    s_cmp_ge_u32 s2, 0x100
    s_cbranch_scc1 L_exit
    s_load_dwordx16 s[8:23], s[0:1], 0
    s_load_dwordx8 s[24:31], s[0:1], 64
    v_lshrrev_b32 v1, 6, v0
    v_and_b32 v0, 63, v0
    v_readfirstlane_b32 s3, v1
    s_and_b32 s4, s2, 7
    s_bfe_u32 s5, s2, 0x40003
    s_lshr_b32 s49, s2, 7
    v_and_b32 v1, 15, v0
    v_lshrrev_b32 v2, 4, v0
    s_and_b32 s7, s4, 1
    s_lshl_b32 s7, s7, 4
    s_add_u32 s32, s5, s7
    s_lshr_b32 s33, s4, 1
    v_lshlrev_b32 v6, 4, v0
    s_cmp_lt_u32 s3, 2
    s_cbranch_scc0 L_e_rest
    s_lshl_b32 s37, s33, 1
    s_add_u32 s37, s37, s49
    s_lshl_b32 s7, s37, 1
    s_add_u32 s7, s7, s3
    v_lshl_add_u32 v4, s7, 2, v2
    v_mul_u32_u24 v4, 9, v4
    s_lshl_b32 s7, s32, 8
    v_lshl_add_u32 v5, v1, 4, s7
    v_lshl_add_u32 v5, v4, 13, v5
    v_lshlrev_b32 v7, 2, v0
    v_mov_b32 v12, 0
    s_waitcnt lgkmcnt(0)
    global_load_dwordx4 v[8:11], v6, s[8:9]
    s_mov_b32 exec_hi, 0
    global_load_dword v12, v7, s[8:9] offset:1024
    s_mov_b32 exec_hi, -1
    global_load_dwordx4 v[64:67], v5, s[12:13] nt
    v_add_u32 v5, 0x2000, v5
    global_load_dwordx4 v[68:71], v5, s[12:13] nt
    v_add_u32 v5, 0x2000, v5
    global_load_dwordx4 v[72:75], v5, s[12:13] nt
    v_add_u32 v5, 0x2000, v5
    global_load_dwordx4 v[76:79], v5, s[12:13] nt
    v_add_u32 v5, 0x2000, v5
    global_load_dwordx4 v[80:83], v5, s[12:13] nt
    v_add_u32 v5, 0x2000, v5
    global_load_dwordx4 v[84:87], v5, s[12:13] nt
    v_add_u32 v5, 0x2000, v5
    global_load_dwordx4 v[88:91], v5, s[12:13] nt
    v_add_u32 v5, 0x2000, v5
    global_load_dwordx4 v[92:95], v5, s[12:13] nt
    v_add_u32 v5, 0x2000, v5
    global_load_dwordx4 v[96:99], v5, s[12:13] nt
    s_load_dword s6, s[30:31], 0
    s_branch L_q0
L_e_rest:
    s_cmp_lt_u32 s3, 4
    s_cbranch_scc1 L_e_house
    s_and_b32 s34, s3, 3
    s_cmp_eq_u32 s49, 0
    s_cbranch_scc0 L_e_ckv
    s_andn2_b32 s37, s32, 3
    s_or_b32 s37, s37, s34
    s_and_b32 s7, s5, 3
    s_lshl_b32 s40, s33, 2
    s_or_b32 s40, s40, s7
    v_lshl_add_u32 v4, s40, 2, v2
    v_lshlrev_b32 v4, 3, v4
    s_lshl_b32 s7, s37, 8
    v_lshl_add_u32 v5, v1, 4, s7
    v_lshl_add_u32 v5, v4, 13, v5
    s_waitcnt lgkmcnt(0)
    s_load_dword s6, s[30:31], 0
    s_barrier
    global_load_dwordx4 v[64:67], v5, s[14:15] nt
    v_add_u32 v5, 0x2000, v5
    global_load_dwordx4 v[68:71], v5, s[14:15] nt
    v_add_u32 v5, 0x2000, v5
    global_load_dwordx4 v[72:75], v5, s[14:15] nt
    v_add_u32 v5, 0x2000, v5
    global_load_dwordx4 v[76:79], v5, s[14:15] nt
    v_add_u32 v5, 0x2000, v5
    s_branch L_quk
L_e_ckv:
    s_lshr_b32 s50, s5, 1
    s_lshl_b32 s7, s4, 3
    s_add_u32 s50, s50, s7
    s_and_b32 s51, s5, 1
    s_and_b32 s7, s3, 1
    s_lshl_b32 s7, s7, 4
    v_xor_b32 v24, s7, v6
    v_xor_b32 v25, 32, v24
    v_xor_b32 v26, 64, v24
    v_xor_b32 v27, 96, v24
    v_xor_b32 v28, 262272, v24
    v_xor_b32 v29, 262304, v24
    v_xor_b32 v30, 262336, v24
    v_xor_b32 v31, 262368, v24
    s_lshl_b32 s39, s34, 13
    s_lshl_b32 s38, s51, 15
    s_add_u32 s38, s38, s39
    s_lshl_b32 s7, s50, 12
    s_waitcnt lgkmcnt(0)
    s_add_u32 s42, s10, s7
    s_addc_u32 s43, s11, 0
    s_load_dword s6, s[30:31], 0
    s_barrier
    s_xor_b32 m0, s38, 0
    s_lshl_b32 s44, m0, 6
    s_add_u32 s44, s42, s44
    s_addc_u32 s45, s43, 0
    global_load_lds_dwordx4 v24, s[44:45] offset:0
    global_load_lds_dwordx4 v25, s[44:45] offset:1024
    global_load_lds_dwordx4 v26, s[44:45] offset:2048
    global_load_lds_dwordx4 v27, s[44:45] offset:3072
    s_branch L_pv
L_e_house:
    s_mov_b32 s35, 262144
    s_lshl_b32 s36, s32, 2
    s_add_u32 s36, s36, s33
    v_mov_b32 v8, -1
    v_mov_b32 v9, -1
    v_mov_b32 v10, -1
    v_mov_b32 v11, -1
    s_cmp_eq_u32 s49, 0
    s_cbranch_scc1 L_e_h1
    s_getpc_b64 s[40:41]
L_pc:
    s_sub_u32 s40, s40, L_pc-sequential_preLN__compressed_kv_cla__dense_activation_silu__decode_kernel
    s_subb_u32 s41, s41, 0
    s_and_b32 s7, s3, 1
    s_lshl_b32 s7, s7, 13
    v_lshl_add_u32 v3, v0, 7, s7
    v_min_u32 v3, L_codeend-sequential_preLN__compressed_kv_cla__dense_activation_silu__decode_kernel-4, v3
    global_load_dword v255, v3, s[40:41]
L_e_h1:
    s_waitcnt lgkmcnt(0)
    s_load_dword s6, s[30:31], 0
    s_cmp_eq_u32 s3, 2
    s_cbranch_scc0 L_e_h3
    s_cmp_eq_u32 s49, 0
    s_cbranch_scc0 L_e_h2
    s_andn2_b32 s7, s32, 3
    s_lshl_b32 s7, s7, 10
    s_and_b32 s40, s5, 3
    s_lshl_b32 s41, s33, 2
    s_or_b32 s40, s40, s41
    s_lshl_b32 s40, s40, 6
    s_add_u32 s7, s7, s40
    s_add_u32 s7, s7, 32768
    v_lshrrev_b32 v12, 2, v1
    v_lshl_add_u32 v12, v12, 10, s7
    v_and_b32 v13, 3, v1
    v_lshl_add_u32 v13, v13, 4, v12
    s_lshl_b32 s7, s36, 8
    s_add_u32 s7, s7, 163584
    v_add_u32 v12, s7, v6
    v_cmp_eq_u32 vcc, 1, v2
    s_mul_i32 s7, s36, 1376
    s_add_u32 s7, s7, 196608
    v_cndmask_b32 v13, v13, v12, vcc
    v_add_u32 v14, s7, v6
    v_add_u32 v12, 512, v14
    v_cmp_le_u32 vcc, 2, v2
    s_lshl_b32 s7, s36, 7
    s_add_u32 s7, s7, 4096
    v_cndmask_b32 v13, v13, v12, vcc
    global_store_dwordx4 v14, v[8:11], s[30:31] sc1
    s_mov_b32 exec_hi, 0x3fffff
    global_store_dwordx4 v13, v[8:11], s[30:31] sc1
    s_mov_b64 exec, 1
    v_mov_b32 v15, s7
    s_waitcnt lgkmcnt(0)
    s_mul_i32 s6, s6, 0x0019660d
    s_add_u32 s6, s6, 0x3c6ef35f
    s_bitset0_b32 s6, 31
    v_mov_b32 v16, s6
    s_barrier
    s_barrier
    s_barrier
    s_waitcnt vmcnt(0)
    global_store_dword v15, v16, s[30:31] sc1
    s_mov_b64 exec, -1
    s_branch L_after_a
L_e_h2:
    s_lshl_b32 s7, s4, 4
    s_add_u32 s7, s7, s5
    s_lshl_b32 s7, s7, 8
    s_add_u32 s7, s7, 786432
    v_lshl_add_u32 v13, v1, 4, s7
    v_lshl_add_u32 v13, v2, 15, v13
    global_store_dwordx4 v13, v[8:11], s[30:31] sc1
    s_branch L_e_h4
L_e_h3:
    s_lshl_b32 s7, s36, 1
    s_add_u32 s7, s7, s49
    s_lshl_b32 s7, s7, 9
    s_add_u32 s7, s7, 524288
    v_add_u32 v13, s7, v6
    s_mov_b32 exec_hi, 0
    global_store_dwordx4 v13, v[8:11], s[30:31] sc1
    s_mov_b32 exec_hi, -1
L_e_h4:
    s_waitcnt lgkmcnt(0)
    s_mul_i32 s6, s6, 0x0019660d
    s_add_u32 s6, s6, 0x3c6ef35f
    s_bitset0_b32 s6, 31
    s_barrier
    s_waitcnt vmcnt(0)
    s_barrier
    s_barrier
    s_branch L_after_a
L_q0:
    s_mov_b32 s35, 262144
    s_lshl_b32 s36, s32, 2
    s_add_u32 s36, s36, s33
    v_and_b32 v13, 1, v1
    v_lshlrev_b32 v13, 4, v13
    v_mov_b32 v14, 0xffff
    v_lshlrev_b32 v13, v13, v14
    v_lshrrev_b32 v14, 1, v1
    v_cmp_eq_u32 vcc, 0, v14
    s_nop 1
    v_cndmask_b32 v16, 0, v13, vcc
    v_cmp_eq_u32 vcc, 1, v14
    s_nop 1
    v_cndmask_b32 v17, 0, v13, vcc
    v_cmp_eq_u32 vcc, 2, v14
    s_nop 1
    v_cndmask_b32 v18, 0, v13, vcc
    v_cmp_eq_u32 vcc, 3, v14
    s_nop 1
    v_cndmask_b32 v19, 0, v13, vcc
    s_mul_i32 s7, s3, 1280
    s_add_u32 s7, s7, 131072
    v_add_u32 v14, s7, v6
    v_add_u32 v7, s7, v7
    v_lshl_add_u32 v4, v4, 1, s7
    s_mov_b32 s34, 0x3f803f80
    s_waitcnt vmcnt(9)
    s_barrier
    ds_write_b128 v14, v[8:11]
    ds_write_b32 v7, v12 offset:1024
    v_dot2_f32_bf16 v20, v8, s34, 0
    v_dot2_f32_bf16 v21, v8, v8, 0
    v_dot2_f32_bf16 v20, v9, s34, v20
    v_dot2_f32_bf16 v21, v9, v9, v21
    v_dot2_f32_bf16 v20, v10, s34, v20
    v_dot2_f32_bf16 v21, v10, v10, v21
    v_dot2_f32_bf16 v20, v11, s34, v20
    v_dot2_f32_bf16 v21, v11, v11, v21
    v_dot2_f32_bf16 v20, v12, s34, v20
    v_dot2_f32_bf16 v21, v12, v12, v21
    s_waitcnt lgkmcnt(0)
    ds_read_u16 v24, v4 offset:0
    ds_read_u16 v25, v4 offset:2
    ds_read_u16 v26, v4 offset:4
    ds_read_u16 v27, v4 offset:6
    ds_read_u16 v28, v4 offset:8
    ds_read_u16 v29, v4 offset:10
    ds_read_u16 v30, v4 offset:12
    ds_read_u16 v31, v4 offset:14
    ds_read_u16 v32, v4 offset:16
    s_mul_i32 s6, s6, 0x0019660d
    s_add_u32 s6, s6, 0x3c6ef35f
    s_bitset0_b32 s6, 31
    v_add_f32_dpp v20, v20, v20 quad_perm:[1,0,3,2] row_mask:0xf bank_mask:0xf
    v_add_f32_dpp v21, v21, v21 quad_perm:[1,0,3,2] row_mask:0xf bank_mask:0xf
    s_nop 0
    v_add_f32_dpp v20, v20, v20 quad_perm:[2,3,0,1] row_mask:0xf bank_mask:0xf
    v_add_f32_dpp v21, v21, v21 quad_perm:[2,3,0,1] row_mask:0xf bank_mask:0xf
    s_nop 0
    v_add_f32_dpp v20, v20, v20 row_half_mirror row_mask:0xf bank_mask:0xf
    v_add_f32_dpp v21, v21, v21 row_half_mirror row_mask:0xf bank_mask:0xf
    s_nop 0
    v_add_f32_dpp v20, v20, v20 row_mirror row_mask:0xf bank_mask:0xf
    v_add_f32_dpp v21, v21, v21 row_mirror row_mask:0xf bank_mask:0xf
    v_mov_b32 v22, v20
    v_mov_b32 v23, v21
    s_nop 0
    v_permlane16_swap_b32 v20, v22
    v_permlane16_swap_b32 v21, v23
    v_add_f32 v20, v20, v22
    v_add_f32 v21, v21, v23
    v_mov_b32 v22, v20
    v_mov_b32 v23, v21
    s_nop 0
    v_permlane32_swap_b32 v20, v22
    v_permlane32_swap_b32 v21, v23
    v_add_f32 v20, v20, v22
    v_add_f32 v21, v21, v23
    v_mul_f32 v20, 0x3ae38e39, v20
    v_mul_f32 v21, 0x3ae38e39, v21
    v_fma_f32 v21, -v20, v20, v21
    v_max_f32 v21, 0, v21
    v_add_f32 v21, 0x3727c5ac, v21
    v_rsq_f32 v21, v21
    s_nop 0
    v_mul_f32 v21, 0x3e0293ee, v21
    v_mul_f32 v20, v20, v21
    s_waitcnt lgkmcnt(0)
    v_lshlrev_b32 v24, 16, v24
    v_lshlrev_b32 v25, 16, v25
    v_lshlrev_b32 v26, 16, v26
    v_lshlrev_b32 v27, 16, v27
    v_lshlrev_b32 v28, 16, v28
    v_lshlrev_b32 v29, 16, v29
    v_lshlrev_b32 v30, 16, v30
    v_lshlrev_b32 v31, 16, v31
    v_lshlrev_b32 v32, 16, v32
    v_fma_f32 v24, v24, v21, -v20
    v_fma_f32 v25, v25, v21, -v20
    v_fma_f32 v26, v26, v21, -v20
    v_fma_f32 v27, v27, v21, -v20
    v_fma_f32 v28, v28, v21, -v20
    v_fma_f32 v29, v29, v21, -v20
    v_fma_f32 v30, v30, v21, -v20
    v_fma_f32 v31, v31, v21, -v20
    v_fma_f32 v32, v32, v21, -v20
    v_cvt_pk_bf16_f32 v24, v24, v24
    v_cvt_pk_bf16_f32 v25, v25, v25
    v_cvt_pk_bf16_f32 v26, v26, v26
    v_cvt_pk_bf16_f32 v27, v27, v27
    v_cvt_pk_bf16_f32 v28, v28, v28
    v_cvt_pk_bf16_f32 v29, v29, v29
    v_cvt_pk_bf16_f32 v30, v30, v30
    v_cvt_pk_bf16_f32 v31, v31, v31
    v_cvt_pk_bf16_f32 v32, v32, v32
    v_and_b32 v100, v24, v16
    v_and_b32 v101, v24, v17
    v_and_b32 v102, v24, v18
    v_and_b32 v103, v24, v19
    v_and_b32 v104, v25, v16
    v_and_b32 v105, v25, v17
    v_and_b32 v106, v25, v18
    v_and_b32 v107, v25, v19
    v_and_b32 v108, v26, v16
    v_and_b32 v109, v26, v17
    v_and_b32 v110, v26, v18
    v_and_b32 v111, v26, v19
    v_and_b32 v112, v27, v16
    v_and_b32 v113, v27, v17
    v_and_b32 v114, v27, v18
    v_and_b32 v115, v27, v19
    v_and_b32 v116, v28, v16
    v_and_b32 v117, v28, v17
    v_and_b32 v118, v28, v18
    v_and_b32 v119, v28, v19
    v_and_b32 v120, v29, v16
    v_and_b32 v121, v29, v17
    v_and_b32 v122, v29, v18
    v_and_b32 v123, v29, v19
    v_and_b32 v124, v30, v16
    v_and_b32 v125, v30, v17
    v_and_b32 v126, v30, v18
    v_and_b32 v127, v30, v19
    v_and_b32 v128, v31, v16
    v_and_b32 v129, v31, v17
    v_and_b32 v130, v31, v18
    v_and_b32 v131, v31, v19
    v_and_b32 v132, v32, v16
    v_and_b32 v133, v32, v17
    v_and_b32 v134, v32, v18
    v_and_b32 v135, v32, v19
    v_add_u32 v7, 135168, v6
    s_lshl_b32 s7, s32, 3
    s_add_u32 s7, s7, s37
    s_lshl_b32 s7, s7, 9
    s_add_u32 s7, s7, 524288
    v_add_u32 v5, s7, v6
    v_mov_b32 v13, 0xffffff00
    s_and_b32 s38, s6, 0xff
    s_bfe_u32 s39, s6, 0x80008
    s_bfe_u32 s40, s6, 0x80010
    s_lshr_b32 s41, s6, 24
    s_cmp_eq_u32 s3, 0
    s_waitcnt vmcnt(8)
    v_mfma_f32_16x16x32_bf16 v[8:11], v[100:103], v[64:67], 0
    s_waitcnt vmcnt(7)
    v_mfma_f32_16x16x32_bf16 v[8:11], v[104:107], v[68:71], v[8:11]
    s_waitcnt vmcnt(6)
    v_mfma_f32_16x16x32_bf16 v[8:11], v[108:111], v[72:75], v[8:11]
    s_waitcnt vmcnt(5)
    v_mfma_f32_16x16x32_bf16 v[8:11], v[112:115], v[76:79], v[8:11]
    s_waitcnt vmcnt(4)
    v_mfma_f32_16x16x32_bf16 v[8:11], v[116:119], v[80:83], v[8:11]
    s_waitcnt vmcnt(3)
    v_mfma_f32_16x16x32_bf16 v[8:11], v[120:123], v[84:87], v[8:11]
    s_waitcnt vmcnt(2)
    v_mfma_f32_16x16x32_bf16 v[8:11], v[124:127], v[88:91], v[8:11]
    s_waitcnt vmcnt(1)
    v_mfma_f32_16x16x32_bf16 v[8:11], v[128:131], v[92:95], v[8:11]
    s_waitcnt vmcnt(0)
    v_mfma_f32_16x16x32_bf16 v[8:11], v[132:135], v[96:99], v[8:11]
    s_mov_b32 exec_hi, 0
    s_cbranch_scc1 L_q_w0
    s_nop 5
    ds_write_b128 v7, v[8:11]
    s_waitcnt lgkmcnt(0)
    s_barrier
    s_branch L_q_done
L_q_w0:
    s_barrier
    ds_read_b128 v[24:27], v7
    s_nop 2
    s_waitcnt lgkmcnt(0)
    v_pk_add_f32 v[24:25], v[24:25], v[8:9]
    v_pk_add_f32 v[26:27], v[26:27], v[10:11]
    v_and_or_b32 v24, v24, v13, s38
    v_and_or_b32 v25, v25, v13, s39
    v_and_or_b32 v26, v26, v13, s40
    v_and_or_b32 v27, v27, v13, s41
    global_store_dwordx4 v5, v[24:27], s[30:31] sc1
L_q_done:
    s_mov_b32 exec_hi, -1
    s_barrier
L_after_a:
    s_cmp_eq_u32 s49, 0
    s_cbranch_scc0 L_att
    s_branch L_g1_stage
L_quk:
    s_mov_b32 s35, 262144
    s_lshl_b32 s36, s32, 2
    s_add_u32 s36, s36, s33
    s_lshl_b32 s7, s37, 12
    s_add_u32 s7, s7, 524288
    v_lshl_add_u32 v13, v2, 9, s7
    v_lshl_add_u32 v13, v1, 4, v13
    s_lshl_b32 s7, s37, 10
    s_add_u32 s7, s7, 32768
    v_lshl_add_u32 v14, v4, 1, s7
    s_mov_b32 s37, 0x0c0c0400
    s_waitcnt lgkmcnt(0)
    s_mul_i32 s6, s6, 0x0019660d
    s_add_u32 s6, s6, 0x3c6ef35f
    s_bitset0_b32 s6, 31
    s_barrier
    s_barrier
    global_load_dwordx4 v[80:83], v5, s[14:15] nt
    v_add_u32 v5, 0x2000, v5
    global_load_dwordx4 v[84:87], v5, s[14:15] nt
    v_add_u32 v5, 0x2000, v5
    global_load_dwordx4 v[88:91], v5, s[14:15] nt
    v_add_u32 v5, 0x2000, v5
    global_load_dwordx4 v[92:95], v5, s[14:15] nt
    v_add_u32 v5, 0x2000, v5
    s_waitcnt vmcnt(0)
    global_load_dwordx4 v[32:35], v13, s[30:31] offset:0 sc1
    global_load_dwordx4 v[36:39], v13, s[30:31] offset:256 sc1
    global_load_dwordx4 v[40:43], v13, s[30:31] offset:2048 sc1
    global_load_dwordx4 v[44:47], v13, s[30:31] offset:2304 sc1
    s_barrier
    s_branch L_a_chk
L_a_poll:
    global_load_dwordx4 v[32:35], v13, s[30:31] offset:0 sc1
    global_load_dwordx4 v[36:39], v13, s[30:31] offset:256 sc1
    global_load_dwordx4 v[40:43], v13, s[30:31] offset:2048 sc1
    global_load_dwordx4 v[44:47], v13, s[30:31] offset:2304 sc1
    s_sub_u32 s35, s35, 1
    s_cbranch_scc1 L_end
L_a_chk:
    s_waitcnt vmcnt(0)
    v_perm_b32 v48, v33, v32, s37
    v_perm_b32 v49, v35, v34, s37
    v_perm_b32 v50, v37, v36, s37
    v_perm_b32 v51, v39, v38, s37
    v_perm_b32 v52, v41, v40, s37
    v_perm_b32 v53, v43, v42, s37
    v_perm_b32 v54, v45, v44, s37
    v_perm_b32 v55, v47, v46, s37
    v_lshl_or_b32 v48, v49, 16, v48
    v_lshl_or_b32 v49, v51, 16, v50
    v_lshl_or_b32 v50, v53, 16, v52
    v_lshl_or_b32 v51, v55, 16, v54
    v_cmp_ne_u32 vcc, s6, v48
    v_cmp_ne_u32 s[38:39], s6, v49
    v_cmp_ne_u32 s[40:41], s6, v50
    v_cmp_ne_u32 s[42:43], s6, v51
    v_pk_add_f32 v[32:33], v[32:33], v[40:41]
    v_pk_add_f32 v[34:35], v[34:35], v[42:43]
    v_pk_add_f32 v[36:37], v[36:37], v[44:45]
    v_pk_add_f32 v[38:39], v[38:39], v[46:47]
    s_or_b64 vcc, vcc, s[38:39]
    s_or_b64 s[40:41], s[40:41], s[42:43]
    s_or_b64 vcc, vcc, s[40:41]
    s_cbranch_vccnz L_a_poll
    v_permlane32_swap_b32 v32, v36
    v_permlane32_swap_b32 v33, v37
    v_permlane32_swap_b32 v34, v38
    v_permlane32_swap_b32 v35, v39
    v_pk_add_f32 v[32:33], v[32:33], v[36:37]
    v_pk_add_f32 v[34:35], v[34:35], v[38:39]
    s_nop 1
    v_permlane16_swap_b32 v32, v34
    v_permlane16_swap_b32 v33, v35
    v_pk_add_f32 v[32:33], v[32:33], v[34:35]
    v_cvt_pk_bf16_f32 v40, v32, v33
    v_cvt_pk_bf16_f32 v41, v32, v33
    s_nop 1
    v_permlane16_swap_b32 v40, v41
    v_mov_b32 v42, v40
    v_mov_b32 v43, v41
    s_nop 0
    v_permlane32_swap_b32 v40, v42
    v_permlane32_swap_b32 v41, v43
    v_dot2_f32_bf16 v48, v64, v40, 0
    v_dot2_f32_bf16 v49, v68, v40, 0
    v_dot2_f32_bf16 v50, v72, v40, 0
    v_dot2_f32_bf16 v51, v76, v40, 0
    v_dot2_f32_bf16 v52, v80, v40, 0
    v_dot2_f32_bf16 v53, v84, v40, 0
    v_dot2_f32_bf16 v54, v88, v40, 0
    v_dot2_f32_bf16 v55, v92, v40, 0
    v_dot2_f32_bf16 v48, v65, v41, v48
    v_dot2_f32_bf16 v49, v69, v41, v49
    v_dot2_f32_bf16 v50, v73, v41, v50
    v_dot2_f32_bf16 v51, v77, v41, v51
    v_dot2_f32_bf16 v52, v81, v41, v52
    v_dot2_f32_bf16 v53, v85, v41, v53
    v_dot2_f32_bf16 v54, v89, v41, v54
    v_dot2_f32_bf16 v55, v93, v41, v55
    v_dot2_f32_bf16 v48, v66, v42, v48
    v_dot2_f32_bf16 v49, v70, v42, v49
    v_dot2_f32_bf16 v50, v74, v42, v50
    v_dot2_f32_bf16 v51, v78, v42, v51
    v_dot2_f32_bf16 v52, v82, v42, v52
    v_dot2_f32_bf16 v53, v86, v42, v53
    v_dot2_f32_bf16 v54, v90, v42, v54
    v_dot2_f32_bf16 v55, v94, v42, v55
    v_dot2_f32_bf16 v48, v67, v43, v48
    v_dot2_f32_bf16 v49, v71, v43, v49
    v_dot2_f32_bf16 v50, v75, v43, v50
    v_dot2_f32_bf16 v51, v79, v43, v51
    v_dot2_f32_bf16 v52, v83, v43, v52
    v_dot2_f32_bf16 v53, v87, v43, v53
    v_dot2_f32_bf16 v54, v91, v43, v54
    v_dot2_f32_bf16 v55, v95, v43, v55
    v_add_f32_dpp v48, v48, v48 row_ror:8 row_mask:0xf bank_mask:0x3
    v_add_f32_dpp v49, v49, v49 row_ror:8 row_mask:0xf bank_mask:0x3
    v_add_f32_dpp v50, v50, v50 row_ror:8 row_mask:0xf bank_mask:0x3
    v_add_f32_dpp v51, v51, v51 row_ror:8 row_mask:0xf bank_mask:0x3
    v_add_f32_dpp v48, v52, v52 row_ror:8 row_mask:0xf bank_mask:0xc
    v_add_f32_dpp v49, v53, v53 row_ror:8 row_mask:0xf bank_mask:0xc
    v_add_f32_dpp v50, v54, v54 row_ror:8 row_mask:0xf bank_mask:0xc
    v_add_f32_dpp v51, v55, v55 row_ror:8 row_mask:0xf bank_mask:0xc
    v_add_f32_dpp v48, v48, v48 row_half_mirror row_mask:0xf bank_mask:0x5
    v_add_f32_dpp v49, v49, v49 row_half_mirror row_mask:0xf bank_mask:0x5
    s_nop 0
    v_add_f32_dpp v48, v50, v50 row_half_mirror row_mask:0xf bank_mask:0xa
    v_add_f32_dpp v49, v51, v51 row_half_mirror row_mask:0xf bank_mask:0xa
    s_nop 0
    v_add_f32_dpp v48, v48, v48 quad_perm:[1,0,3,2] row_mask:0xf bank_mask:0xf
    v_add_f32_dpp v49, v49, v49 quad_perm:[1,0,3,2] row_mask:0xf bank_mask:0xf
    s_nop 0
    v_add_f32_dpp v48, v48, v48 quad_perm:[2,3,0,1] row_mask:0xf bank_mask:0xf
    v_add_f32_dpp v49, v49, v49 quad_perm:[2,3,0,1] row_mask:0xf bank_mask:0xf
    v_cvt_pk_bf16_f32 v56, v48, v49
    s_mov_b32 s38, 0x00010001
    s_nop 0
    v_mov_b32_dpp v57, v56 row_shl:4 row_mask:0xf bank_mask:0xf
    v_mov_b32_dpp v58, v56 row_shl:8 row_mask:0xf bank_mask:0xf
    v_mov_b32_dpp v59, v56 row_shl:12 row_mask:0xf bank_mask:0xf
    s_mov_b32 exec_lo, s38
    s_mov_b32 exec_hi, s38
    global_store_dwordx4 v14, v[56:59], s[30:31] sc1
    s_mov_b64 exec, -1
    s_barrier
    s_branch L_g1_other
L_g1_stage:
    s_lshl_b32 s7, s33, 2
    s_and_b32 s34, s5, 3
    s_add_u32 s7, s7, s34
    s_lshl_b32 s7, s7, 2
    s_add_u32 s7, s7, s3
    s_lshl_b32 s7, s7, 16
    s_andn2_b32 s34, s32, 3
    s_lshl_b32 s34, s34, 8
    s_add_u32 s7, s7, s34
    v_min_u32 v9, 8, v0
    v_lshl_add_u32 v4, v9, 7, s7
    s_lshl_b32 s40, s5, 2
    s_add_u32 s40, s40, s3
    s_mul_i32 s43, s4, 1152
    s_mul_i32 s42, s43, 576
    s_cmp_lt_u32 s5, 9
    s_cbranch_scc0 L_g1_pf
    s_lshl_b32 s41, s3, 10
    v_lshrrev_b32 v8, 3, v0
    v_lshrrev_b32 v5, 5, v0
    v_xor_b32 v8, v8, v5
    s_lshr_b32 s7, s3, 1
    v_and_b32 v6, 7, v0
    v_xor_b32 v5, s7, v6
    v_lshlrev_b32 v5, 4, v5
    s_lshl_b32 s7, s4, 9
    s_lshl_b32 s34, s3, 3
    s_add_u32 s7, s7, s34
    v_add_u32 v8, s7, v8
    v_mul_u32_u24 v8, 1152, v8
    s_lshl_b32 s7, s5, 7
    v_add3_u32 v8, v8, v5, s7
    s_mul_i32 s7, s40, 1152
    s_add_u32 s7, s7, s42
    v_lshl_add_u32 v10, v9, 7, s7
    s_add_u32 s7, s40, 432
    s_mul_i32 s7, s7, 9216
    s_add_u32 s7, s7, s43
    v_lshl_add_u32 v11, v9, 7, s7
    v_bfe_u32 v20, v0, 2, 2
    v_and_b32 v21, 1, v0
    v_bfe_u32 v22, v0, 1, 1
    v_and_b32 v23, 1, v2
    s_lshr_b32 s7, s3, 1
    s_lshl_b32 s7, s7, 2
    s_and_b32 s34, s3, 1
    s_add_u32 s7, s7, s34
    v_lshl_add_u32 v13, v21, 1, s7
    v_and_b32 v14, 1, v20
    v_lshl_or_b32 v15, v23, 2, v14
    v_xor_b32 v13, v13, v15
    v_lshlrev_b32 v13, 4, v13
    v_lshl_add_u32 v13, v22, 3, v13
    v_lshl_add_u32 v13, v14, 11, v13
    v_lshl_add_u32 v13, v2, 12, v13
    v_lshrrev_b32 v14, 1, v20
    v_mul_u32_u24 v14, 640, v14
    v_add_u32 v13, v13, v14
    v_xor_b32 v14, 0x80, v13
    s_lshl_b32 s7, s4, 12
    s_add_u32 s7, s7, 163840
    v_lshl_add_u32 v28, v20, 8, s7
    v_lshl_add_u32 v28, v2, 6, v28
    v_and_b32 v29, 3, v0
    v_lshl_add_u32 v28, v29, 4, v28
    s_lshl_b32 s7, s4, 11
    s_add_u32 s7, s7, 442368
    v_lshl_add_u32 v30, v1, 7, s7
    s_mul_i32 s7, s4, 9
    s_add_u32 s7, s7, s5
    s_lshl_b32 s7, s7, 7
    s_add_u32 s34, s7, 655360
    v_mul_u32_u24 v38, 9216, v6
    v_add_u32 v38, s34, v38
    v_mov_b32 v39, s6
    s_lshl_b32 s34, s3, 5
    s_add_u32 s7, s7, s34
    s_add_u32 s7, s7, 196608
    v_lshl_add_u32 v29, v0, 1, s7
    s_barrier
    s_barrier
    s_mov_b64 exec, 0xff
    global_load_dword v255, v4, s[16:17]
    v_add_u32 v4, 0x2000, v4
    global_load_dword v255, v4, s[16:17]
    v_add_u32 v4, 0x2000, v4
    global_load_dword v255, v4, s[16:17]
    v_add_u32 v4, 0x2000, v4
    global_load_dword v255, v4, s[16:17]
    s_waitcnt vmcnt(3)
    v_add_u32 v4, 0x2000, v4
    global_load_dword v255, v4, s[16:17]
    s_waitcnt vmcnt(3)
    v_add_u32 v4, 0x2000, v4
    global_load_dword v255, v4, s[16:17]
    v_add_u32 v4, 0x2000, v4
    global_load_dword v255, v4, s[16:17]
    s_waitcnt vmcnt(6)
    v_add_u32 v4, 0x2000, v4
    global_load_dword v255, v4, s[16:17]
    s_waitcnt vmcnt(6)
    s_add_u32 m0, s41, 0
    s_mov_b64 exec, -1
    global_load_lds_dwordx4 v8, s[18:19] nt
    s_waitcnt vmcnt(6)
    s_add_u32 m0, s41, 4096
    v_add_u32 v8, 36864, v8
    v_xor_b32 v8, 64, v8
    global_load_lds_dwordx4 v8, s[18:19] nt
    s_waitcnt vmcnt(6)
    s_add_u32 m0, s41, 8192
    v_add_u32 v8, 36864, v8
    v_xor_b32 v8, 64, v8
    global_load_lds_dwordx4 v8, s[18:19] nt
    s_waitcnt vmcnt(6)
    s_add_u32 m0, s41, 12288
    v_add_u32 v8, 36864, v8
    v_xor_b32 v8, 64, v8
    global_load_lds_dwordx4 v8, s[18:19] nt
    s_waitcnt vmcnt(6)
    s_add_u32 m0, s41, 16384
    v_add_u32 v8, 36864, v8
    v_xor_b32 v8, 64, v8
    global_load_lds_dwordx4 v8, s[18:19] nt
    s_waitcnt vmcnt(6)
    s_add_u32 m0, s41, 20480
    v_add_u32 v8, 36864, v8
    v_xor_b32 v8, 64, v8
    global_load_lds_dwordx4 v8, s[18:19] nt
    s_waitcnt vmcnt(6)
    s_add_u32 m0, s41, 24576
    v_add_u32 v8, 36864, v8
    v_xor_b32 v8, 64, v8
    global_load_lds_dwordx4 v8, s[18:19] nt
    s_waitcnt vmcnt(6)
    s_add_u32 m0, s41, 28672
    v_add_u32 v8, 36864, v8
    v_xor_b32 v8, 64, v8
    global_load_lds_dwordx4 v8, s[18:19] nt
    s_waitcnt vmcnt(6)
    s_add_u32 m0, s41, 32768
    v_add_u32 v8, 36864, v8
    v_xor_b32 v8, 64, v8
    global_load_lds_dwordx4 v8, s[18:19] nt
    s_waitcnt vmcnt(6)
    s_add_u32 m0, s41, 36864
    v_add_u32 v8, 36864, v8
    v_xor_b32 v8, 64, v8
    global_load_lds_dwordx4 v8, s[18:19] nt
    s_waitcnt vmcnt(6)
    s_add_u32 m0, s41, 40960
    v_add_u32 v8, 36864, v8
    v_xor_b32 v8, 64, v8
    global_load_lds_dwordx4 v8, s[18:19] nt
    s_waitcnt vmcnt(6)
    s_add_u32 m0, s41, 45056
    v_add_u32 v8, 36864, v8
    v_xor_b32 v8, 64, v8
    global_load_lds_dwordx4 v8, s[18:19] nt
    s_waitcnt vmcnt(6)
    s_add_u32 m0, s41, 49152
    v_add_u32 v8, 36864, v8
    v_xor_b32 v8, 64, v8
    global_load_lds_dwordx4 v8, s[18:19] nt
    s_waitcnt vmcnt(6)
    s_add_u32 m0, s41, 53248
    v_add_u32 v8, 36864, v8
    v_xor_b32 v8, 64, v8
    global_load_lds_dwordx4 v8, s[18:19] nt
    s_waitcnt vmcnt(6)
    s_add_u32 m0, s41, 57344
    v_add_u32 v8, 36864, v8
    v_xor_b32 v8, 64, v8
    global_load_lds_dwordx4 v8, s[18:19] nt
    s_waitcnt vmcnt(6)
    s_add_u32 m0, s41, 61440
    v_add_u32 v8, 36864, v8
    v_xor_b32 v8, 64, v8
    global_load_lds_dwordx4 v8, s[18:19] nt
    s_waitcnt vmcnt(6)
    s_mov_b64 exec, 0x1ff
    global_load_dword v255, v11, s[22:23]
    s_waitcnt vmcnt(6)
    v_add_u32 v11, 331776, v11
    global_load_dword v255, v11, s[22:23]
    s_waitcnt vmcnt(6)
    v_add_u32 v11, 331776, v11
    global_load_dword v255, v11, s[22:23]
    s_waitcnt vmcnt(6)
    v_add_u32 v11, 331776, v11
    global_load_dword v255, v11, s[22:23]
    s_mov_b64 exec, -1
    s_waitcnt vmcnt(4)
    s_barrier
    ds_read_b64_tr_b16 v[128:129], v13 offset:0
    ds_read_b64_tr_b16 v[130:131], v13 offset:1024
    ds_read_b64_tr_b16 v[132:133], v14 offset:0
    ds_read_b64_tr_b16 v[134:135], v14 offset:1024
    ds_read_b64_tr_b16 v[136:137], v13 offset:256
    ds_read_b64_tr_b16 v[138:139], v13 offset:1280
    ds_read_b64_tr_b16 v[140:141], v14 offset:256
    ds_read_b64_tr_b16 v[142:143], v14 offset:1280
    ds_read_b64_tr_b16 v[144:145], v13 offset:16384
    ds_read_b64_tr_b16 v[146:147], v13 offset:17408
    ds_read_b64_tr_b16 v[148:149], v14 offset:16384
    ds_read_b64_tr_b16 v[150:151], v14 offset:17408
    ds_read_b64_tr_b16 v[152:153], v13 offset:16640
    ds_read_b64_tr_b16 v[154:155], v13 offset:17664
    ds_read_b64_tr_b16 v[156:157], v14 offset:16640
    ds_read_b64_tr_b16 v[158:159], v14 offset:17664
    ds_read_b64_tr_b16 v[160:161], v13 offset:32768
    ds_read_b64_tr_b16 v[162:163], v13 offset:33792
    ds_read_b64_tr_b16 v[164:165], v14 offset:32768
    ds_read_b64_tr_b16 v[166:167], v14 offset:33792
    ds_read_b64_tr_b16 v[168:169], v13 offset:33024
    ds_read_b64_tr_b16 v[170:171], v13 offset:34048
    ds_read_b64_tr_b16 v[172:173], v14 offset:33024
    ds_read_b64_tr_b16 v[174:175], v14 offset:34048
    ds_read_b64_tr_b16 v[176:177], v13 offset:49152
    ds_read_b64_tr_b16 v[178:179], v13 offset:50176
    ds_read_b64_tr_b16 v[180:181], v14 offset:49152
    ds_read_b64_tr_b16 v[182:183], v14 offset:50176
    ds_read_b64_tr_b16 v[184:185], v13 offset:49408
    ds_read_b64_tr_b16 v[186:187], v13 offset:50432
    ds_read_b64_tr_b16 v[188:189], v14 offset:49408
    ds_read_b64_tr_b16 v[190:191], v14 offset:50432
    s_mov_b64 exec, 0xffff
L_hd_poll:
    global_load_dword v5, v30, s[30:31] sc1
    s_sub_u32 s35, s35, 1
    s_cbranch_scc1 L_end
    s_waitcnt vmcnt(0)
    v_cmp_ne_u32 vcc, s6, v5
    s_cbranch_vccnz L_hd_poll
    s_mov_b64 exec, -1
L_d_poll:
    global_load_dwordx4 v[40:43], v28, s[30:31] offset:0 sc1
    global_load_dwordx4 v[44:47], v28, s[30:31] offset:1024 sc1
    global_load_dwordx4 v[48:51], v28, s[30:31] offset:2048 sc1
    global_load_dwordx4 v[52:55], v28, s[30:31] offset:3072 sc1
    s_sub_u32 s35, s35, 1
    s_cbranch_scc1 L_end
    s_waitcnt vmcnt(0) lgkmcnt(0)
    v_max3_u32 v35, v40, v44, v48
    v_max_u32 v35, v35, v52
    v_cmp_eq_u32 vcc, -1, v35
    s_cbranch_vccnz L_d_poll
    s_cmp_eq_u32 s3, 0
    s_cbranch_scc0 L_no_he
    s_mov_b64 exec, 0xff
    global_store_dword v38, v39, s[30:31] sc1
    s_mov_b64 exec, -1
L_no_he:
    v_mfma_f32_16x16x32_bf16 v[80:83], v[40:43], v[128:131], 0
    v_mfma_f32_16x16x32_bf16 v[80:83], v[44:47], v[144:147], v[80:83]
    v_mfma_f32_16x16x32_bf16 v[80:83], v[48:51], v[160:163], v[80:83]
    v_mfma_f32_16x16x32_bf16 v[80:83], v[52:55], v[176:179], v[80:83]
    v_mfma_f32_16x16x32_bf16 v[84:87], v[40:43], v[132:135], 0
    v_mfma_f32_16x16x32_bf16 v[84:87], v[44:47], v[148:151], v[84:87]
    v_mfma_f32_16x16x32_bf16 v[84:87], v[48:51], v[164:167], v[84:87]
    v_mfma_f32_16x16x32_bf16 v[84:87], v[52:55], v[180:183], v[84:87]
    v_mfma_f32_16x16x32_bf16 v[88:91], v[40:43], v[136:139], 0
    v_mfma_f32_16x16x32_bf16 v[88:91], v[44:47], v[152:155], v[88:91]
    v_mfma_f32_16x16x32_bf16 v[88:91], v[48:51], v[168:171], v[88:91]
    v_mfma_f32_16x16x32_bf16 v[88:91], v[52:55], v[184:187], v[88:91]
    v_mfma_f32_16x16x32_bf16 v[92:95], v[40:43], v[140:143], 0
    v_mfma_f32_16x16x32_bf16 v[92:95], v[44:47], v[156:159], v[92:95]
    v_mfma_f32_16x16x32_bf16 v[92:95], v[48:51], v[172:175], v[92:95]
    v_mfma_f32_16x16x32_bf16 v[92:95], v[52:55], v[188:191], v[92:95]
    v_add_f32 v56, v80, v85
    s_nop 2
    v_add_f32 v56, v56, v90
    s_nop 2
    v_add_f32 v56, v56, v95
    v_mov_b32 v57, v56
    s_nop 1
    v_permlane16_swap_b32 v56, v57
    v_add_f32 v56, v56, v57
    v_mov_b32 v57, v56
    s_nop 1
    v_permlane32_swap_b32 v56, v57
    v_add_f32 v56, v56, v57
    s_nop 1
    v_mov_b32_dpp v57, v56 quad_perm:[1,1,3,3] row_mask:0xf bank_mask:0xf
    v_cvt_pk_bf16_f32 v60, v56, v57
    s_nop 1
    v_mov_b32_dpp v61, v60 row_shl:2 row_mask:0xf bank_mask:0xf
    v_mov_b32_dpp v62, v60 row_shl:4 row_mask:0xf bank_mask:0xf
    v_mov_b32_dpp v63, v60 row_shl:6 row_mask:0xf bank_mask:0xf
    s_mov_b64 exec, 0x101
    global_store_dwordx4 v29, v[60:63], s[30:31] sc1
    s_branch L_end
L_g1_pf:
    s_sub_u32 s40, s40, 36
    v_lshl_add_u32 v10, v9, 7, s43
    v_add_u32 v11, 3972096, v10
    s_mul_i32 s7, s40, 9216
    v_add_u32 v10, s7, v10
    v_lshl_add_u32 v12, v9, 7, s42
    v_add_u32 v13, 662400, v12
    s_mul_i32 s7, s40, 1152
    s_add_u32 s7, s7, 589824
    v_add_u32 v12, s7, v12
    s_barrier
    s_barrier
    s_mov_b64 exec, 0xff
    global_load_dword v255, v4, s[16:17]
    v_add_u32 v4, 0x2000, v4
    global_load_dword v255, v4, s[16:17]
    v_add_u32 v4, 0x2000, v4
    global_load_dword v255, v4, s[16:17]
    v_add_u32 v4, 0x2000, v4
    global_load_dword v255, v4, s[16:17]
    s_waitcnt vmcnt(3)
    v_add_u32 v4, 0x2000, v4
    global_load_dword v255, v4, s[16:17]
    s_waitcnt vmcnt(3)
    v_add_u32 v4, 0x2000, v4
    global_load_dword v255, v4, s[16:17]
    v_add_u32 v4, 0x2000, v4
    global_load_dword v255, v4, s[16:17]
    s_waitcnt vmcnt(6)
    v_add_u32 v4, 0x2000, v4
    global_load_dword v255, v4, s[16:17]
    s_mov_b64 exec, 0x1ff
    s_mov_b32 s7, 16
L_pf1:
    s_waitcnt vmcnt(6)
    global_load_dword v255, v10, s[22:23]
    v_add_u32 v10, 258048, v10
    v_min_u32 v10, v10, v11
    s_sub_u32 s7, s7, 1
    s_cmp_lg_u32 s7, 0
    s_cbranch_scc1 L_pf1
    s_mov_b32 s7, 3
L_pf2:
    s_waitcnt vmcnt(6)
    global_load_dword v255, v12, s[24:25]
    v_add_u32 v12, 32256, v12
    v_min_u32 v12, v12, v13
    s_sub_u32 s7, s7, 1
    s_cmp_lg_u32 s7, 0
    s_cbranch_scc1 L_pf2
    s_mov_b64 exec, -1
    s_waitcnt vmcnt(0)
L_g1_other:
    s_add_u32 s5, s5, 7
    s_and_b32 s7, s5, 0x1e
    s_cmp_eq_u32 s7, 16
    s_cbranch_scc1 L_ffn
    s_cmp_ge_u32 s2, 110
    s_cbranch_scc0 L_end
    s_cmp_eq_u32 s3, 0
    s_cbranch_scc0 L_end
    s_sub_u32 s34, s2, 110
    s_lshl_b32 s34, s34, 6
    v_lshrrev_b32 v4, 2, v0
    v_mul_u32_u24 v4, 1152, v4
    v_and_b32 v5, 3, v0
    v_lshl_add_u32 v4, v5, 4, v4
    s_add_u32 s7, s34, 196608
    v_add_u32 v80, s7, v4
    v_and_b32 v7, 1, v2
    v_lshl_add_u32 v6, v7, 5, s34
    v_lshl_add_u32 v6, v5, 3, v6
    global_load_dwordx2 v[8:9], v6, s[8:9]
    v_add_u32 v81, 18432, v80
    v_add_u32 v82, 36864, v80
    v_add_u32 v83, 55296, v80
    v_add_u32 v84, 73728, v80
    v_add_u32 v85, 92160, v80
    v_add_u32 v86, 110592, v80
    v_add_u32 v87, 129024, v80
    v_add_u32 v88, 147456, v80
    v_add_u32 v89, 165888, v80
    v_and_b32 v13, 1, v1
    v_lshlrev_b32 v13, 4, v13
    v_mov_b32 v14, 0xffff
    v_lshlrev_b32 v13, v13, v14
    v_lshrrev_b32 v14, 1, v1
    v_cmp_eq_u32 vcc, 0, v14
    s_nop 1
    v_cndmask_b32 v16, 0, v13, vcc
    v_cmp_eq_u32 vcc, 1, v14
    s_nop 1
    v_cndmask_b32 v17, 0, v13, vcc
    v_cmp_eq_u32 vcc, 2, v14
    s_nop 1
    v_cndmask_b32 v18, 0, v13, vcc
    v_cmp_eq_u32 vcc, 3, v14
    s_nop 1
    v_cndmask_b32 v19, 0, v13, vcc
    s_mov_b32 s37, 0x3f803f80
    v_and_b32 v16, s37, v16
    v_mov_b32 v132, 0
    v_and_b32 v17, s37, v17
    v_mov_b32 v133, 0
    v_and_b32 v18, s37, v18
    v_mov_b32 v134, 0
    v_and_b32 v19, s37, v19
    v_mov_b32 v135, 0
    v_cmp_gt_u32 vcc, 4, v1
    v_and_b32 v10, 7, v0
    v_mul_u32_u24 v10, 2304, v10
    s_lshl_b32 s7, s34, 1
    s_add_u32 s7, s7, 409600
    v_add_u32 v10, s7, v10
    s_waitcnt vmcnt(0)
    v_cndmask_b32 v8, 0, v8, vcc
    v_cndmask_b32 v9, 0, v9, vcc
    v_lshlrev_b32 v56, 16, v8
    v_and_b32 v57, 0xffff0000, v8
    v_lshlrev_b32 v58, 16, v9
    v_and_b32 v59, 0xffff0000, v9
    s_mov_b64 exec, 0xff
L_hf_poll:
    global_load_dword v12, v10, s[30:31] sc1
    s_sub_u32 s35, s35, 1
    s_cbranch_scc1 L_end
    s_waitcnt vmcnt(0)
    v_cmp_ne_u32 vcc, s6, v12
    s_cbranch_vccnz L_hf_poll
    s_mov_b64 exec, -1
L_f_poll:
    global_load_dwordx4 v[96:99], v80, s[30:31] sc1
    global_load_dwordx4 v[100:103], v81, s[30:31] sc1
    global_load_dwordx4 v[104:107], v82, s[30:31] sc1
    global_load_dwordx4 v[108:111], v83, s[30:31] sc1
    global_load_dwordx4 v[112:115], v84, s[30:31] sc1
    global_load_dwordx4 v[116:119], v85, s[30:31] sc1
    global_load_dwordx4 v[120:123], v86, s[30:31] sc1
    global_load_dwordx4 v[124:127], v87, s[30:31] sc1
    global_load_dwordx4 v[128:131], v88, s[30:31] sc1
    s_mov_b32 exec_hi, 0
    global_load_dwordx4 v[132:135], v89, s[30:31] sc1
    s_mov_b32 exec_hi, -1
    s_sub_u32 s35, s35, 1
    s_cbranch_scc1 L_end
    s_waitcnt vmcnt(0)
    v_max3_u32 v35, v96, v100, v104
    v_max3_u32 v36, v108, v112, v116
    v_max3_u32 v35, v35, v120, v124
    v_max3_u32 v36, v36, v128, v132
    v_max_u32 v35, v35, v36
    v_cmp_eq_u32 vcc, -1, v35
    s_cbranch_vccnz L_f_poll
    v_mfma_f32_16x16x32_bf16 v[56:59], v[16:19], v[96:99], v[56:59]
    v_mfma_f32_16x16x32_bf16 v[56:59], v[16:19], v[100:103], v[56:59]
    v_mfma_f32_16x16x32_bf16 v[56:59], v[16:19], v[104:107], v[56:59]
    v_mfma_f32_16x16x32_bf16 v[56:59], v[16:19], v[108:111], v[56:59]
    v_mfma_f32_16x16x32_bf16 v[56:59], v[16:19], v[112:115], v[56:59]
    v_mfma_f32_16x16x32_bf16 v[56:59], v[16:19], v[116:119], v[56:59]
    v_mfma_f32_16x16x32_bf16 v[56:59], v[16:19], v[120:123], v[56:59]
    v_mfma_f32_16x16x32_bf16 v[56:59], v[16:19], v[124:127], v[56:59]
    v_mfma_f32_16x16x32_bf16 v[56:59], v[16:19], v[128:131], v[56:59]
    v_mfma_f32_16x16x32_bf16 v[56:59], v[16:19], v[132:135], v[56:59]
    s_nop 7
    v_add_f32_dpp v56, v56, v56 row_ror:8 row_mask:0xf bank_mask:0xf
    v_add_f32_dpp v57, v57, v57 row_ror:8 row_mask:0xf bank_mask:0xf
    v_add_f32_dpp v58, v58, v58 row_ror:8 row_mask:0xf bank_mask:0xf
    v_add_f32_dpp v59, v59, v59 row_ror:8 row_mask:0xf bank_mask:0xf
    v_add_f32_dpp v56, v56, v56 row_ror:4 row_mask:0xf bank_mask:0xf
    v_add_f32_dpp v57, v57, v57 row_ror:4 row_mask:0xf bank_mask:0xf
    v_add_f32_dpp v58, v58, v58 row_ror:4 row_mask:0xf bank_mask:0xf
    v_add_f32_dpp v59, v59, v59 row_ror:4 row_mask:0xf bank_mask:0xf
    v_cvt_pk_bf16_f32 v56, v56, v57
    v_cvt_pk_bf16_f32 v57, v58, v59
    s_mov_b64 exec, 0x000f000f
    global_store_dwordx2 v6, v[56:57], s[26:27]
    s_cmp_eq_u32 s2, 127
    s_cbranch_scc0 L_red_done
    v_mov_b32 v4, 0
    v_mov_b32 v5, s6
    s_mov_b64 exec, 1
    global_store_dword v4, v5, s[30:31]
L_red_done:
    s_branch L_end
L_att:
    s_and_b32 s51, s5, 1
    v_lshlrev_b32 v4, 1, v1
    v_and_b32 v4, 15, v4
    v_lshrrev_b32 v5, 3, v1
    v_or_b32 v4, v4, v5
    v_lshlrev_b32 v4, 4, v4
    v_lshl_add_u32 v4, v2, 8, v4
    v_lshl_add_u32 v4, v1, 10, v4
    s_lshl_b32 s7, s3, 14
    v_add_u32 v5, s7, v4
    v_add_u32 v4, 131072, v4
    v_xor_b32 v32, 0, v4
    v_xor_b32 v48, 0, v5
    v_xor_b32 v33, 16, v4
    v_xor_b32 v49, 16, v5
    v_xor_b32 v34, 32, v4
    v_xor_b32 v50, 32, v5
    v_xor_b32 v35, 48, v4
    v_xor_b32 v51, 48, v5
    v_xor_b32 v36, 64, v4
    v_xor_b32 v52, 64, v5
    v_xor_b32 v37, 80, v4
    v_xor_b32 v53, 80, v5
    v_xor_b32 v38, 96, v4
    v_xor_b32 v54, 96, v5
    v_xor_b32 v39, 112, v4
    v_xor_b32 v55, 112, v5
    v_xor_b32 v40, 128, v4
    v_xor_b32 v56, 128, v5
    v_xor_b32 v41, 144, v4
    v_xor_b32 v57, 144, v5
    v_xor_b32 v42, 160, v4
    v_xor_b32 v58, 160, v5
    v_xor_b32 v43, 176, v4
    v_xor_b32 v59, 176, v5
    v_xor_b32 v44, 192, v4
    v_xor_b32 v60, 192, v5
    v_xor_b32 v45, 208, v4
    v_xor_b32 v61, 208, v5
    v_xor_b32 v46, 224, v4
    v_xor_b32 v62, 224, v5
    v_xor_b32 v47, 240, v4
    v_xor_b32 v63, 240, v5
    v_lshlrev_b32 v29, 2, v1
    v_add_u32 v29, 151552, v29
    v_mov_b32 v5, 0xff800000
    ds_write_b32 v29, v5
    v_and_b32 v5, 1, v2
    v_xor_b32 v5, s51, v5
    v_lshlrev_b32 v5, 6, v5
    s_lshl_b32 s7, s3, 4
    v_add3_u32 v5, v5, v1, s7
    v_lshlrev_b32 v5, 7, v5
    v_add_u32 v21, 4096, v5
    s_and_b32 s7, s3, 1
    s_lshl_b32 s7, s7, 3
    s_lshr_b32 s34, s3, 1
    s_or_b32 s7, s7, s34
    v_xor_b32 v5, s7, v0
    s_lshl_b32 s7, s51, 14
    s_lshl_b32 s34, s3, 12
    s_add_u32 s7, s7, s34
    s_add_u32 s7, s7, 32768
    v_lshl_add_u32 v24, v5, 4, s7
    v_xor_b32 v25, 32, v24
    v_xor_b32 v26, 64, v24
    v_xor_b32 v27, 0x60, v24
    s_add_u32 s7, s34, 131072
    v_lshl_add_u32 v28, v0, 4, s7
    s_lshl_b32 s7, s3, 10
    s_add_u32 s7, s7, 147456
    v_lshl_add_u32 v30, v0, 4, s7
    s_lshl_b32 s7, s3, 8
    s_add_u32 s7, s7, 153600
    v_lshl_add_u32 v31, v0, 2, s7
    s_lshl_b32 s7, s4, 4
    s_add_u32 s7, s7, s5
    s_lshl_b32 s7, s7, 8
    s_add_u32 s7, s7, 786432
    v_lshl_add_u32 v22, v1, 4, s7
    v_lshl_add_u32 v22, v2, 15, v22
    v_mov_b32 v18, s6
    v_mov_b32 v19, s6
    s_waitcnt vmcnt(0)
    s_barrier
    s_mov_b32 exec_hi, 0
    global_load_dword v5, v21, s[30:31] sc1
    s_mov_b32 exec_hi, -1
    ds_read_b128 v[64:67], v48
    ds_read_b128 v[68:71], v49
    ds_read_b128 v[72:75], v50
    ds_read_b128 v[76:79], v51
    ds_read_b128 v[80:83], v52
    ds_read_b128 v[84:87], v53
    ds_read_b128 v[88:91], v54
    ds_read_b128 v[92:95], v55
    ds_read_b128 v[96:99], v56
    ds_read_b128 v[100:103], v57
    ds_read_b128 v[104:107], v58
    ds_read_b128 v[108:111], v59
    ds_read_b128 v[112:115], v60
    ds_read_b128 v[116:119], v61
    ds_read_b128 v[120:123], v62
    ds_read_b128 v[124:127], v63
    v_add_u32 v48, 0x10000, v48
    v_add_u32 v49, 0x10000, v49
    v_add_u32 v50, 0x10000, v50
    v_add_u32 v51, 0x10000, v51
    v_add_u32 v52, 0x10000, v52
    v_add_u32 v53, 0x10000, v53
    v_add_u32 v54, 0x10000, v54
    v_add_u32 v55, 0x10000, v55
    v_add_u32 v56, 0x10000, v56
    v_add_u32 v57, 0x10000, v57
    v_add_u32 v58, 0x10000, v58
    v_add_u32 v59, 0x10000, v59
    v_add_u32 v60, 0x10000, v60
    v_add_u32 v61, 0x10000, v61
    v_add_u32 v62, 0x10000, v62
    v_add_u32 v63, 0x10000, v63
    s_mov_b32 exec_hi, 0
    s_branch L_flag_chk
L_flag_poll:
    global_load_dword v5, v21, s[30:31] sc1
    s_sub_u32 s35, s35, 1
    s_cbranch_scc1 L_end
L_flag_chk:
    s_waitcnt vmcnt(0)
    v_cmp_ne_u32 vcc, s6, v5
    s_cbranch_vccnz L_flag_poll
    s_mov_b32 exec_hi, -1
    s_branch L_q_ld
L_q_again:
    s_sub_u32 s35, s35, 1
    s_cbranch_scc1 L_end
L_q_ld:
    global_load_dwordx4 v[192:195], v24, s[30:31] offset:0 sc1
    global_load_dwordx4 v[196:199], v25, s[30:31] offset:1024 sc1
    global_load_dwordx4 v[200:203], v26, s[30:31] offset:2048 sc1
    global_load_dwordx4 v[204:207], v27, s[30:31] offset:3072 sc1
    s_waitcnt vmcnt(0)
    v_max3_u32 v4, v192, v196, v200
    v_max_u32 v4, v4, v204
    v_cmp_eq_u32 vcc, -1, v4
    s_cbranch_vccnz L_q_again
    ds_write_b128 v28, v[192:195] offset:0
    ds_write_b128 v28, v[196:199] offset:1024
    ds_write_b128 v28, v[200:203] offset:2048
    ds_write_b128 v28, v[204:207] offset:3072
    s_waitcnt lgkmcnt(0)
    s_barrier
    ds_read_b128 v[192:195], v32
    ds_read_b128 v[128:131], v48
    ds_read_b128 v[196:199], v33
    ds_read_b128 v[132:135], v49
    ds_read_b128 v[200:203], v34
    ds_read_b128 v[136:139], v50
    s_waitcnt lgkmcnt(5)
    v_mfma_f32_16x16x32_bf16 v[8:11], v[64:67], v[192:195], 0
    ds_read_b128 v[204:207], v35
    s_waitcnt lgkmcnt(5)
    v_mfma_f32_16x16x32_bf16 v[12:15], v[128:131], v[192:195], 0
    ds_read_b128 v[140:143], v51
    s_waitcnt lgkmcnt(5)
    v_mfma_f32_16x16x32_bf16 v[8:11], v[68:71], v[196:199], v[8:11]
    ds_read_b128 v[208:211], v36
    s_waitcnt lgkmcnt(5)
    v_mfma_f32_16x16x32_bf16 v[12:15], v[132:135], v[196:199], v[12:15]
    ds_read_b128 v[144:147], v52
    s_waitcnt lgkmcnt(5)
    v_mfma_f32_16x16x32_bf16 v[8:11], v[72:75], v[200:203], v[8:11]
    ds_read_b128 v[212:215], v37
    s_waitcnt lgkmcnt(5)
    v_mfma_f32_16x16x32_bf16 v[12:15], v[136:139], v[200:203], v[12:15]
    ds_read_b128 v[148:151], v53
    s_waitcnt lgkmcnt(5)
    v_mfma_f32_16x16x32_bf16 v[8:11], v[76:79], v[204:207], v[8:11]
    ds_read_b128 v[216:219], v38
    s_waitcnt lgkmcnt(5)
    v_mfma_f32_16x16x32_bf16 v[12:15], v[140:143], v[204:207], v[12:15]
    ds_read_b128 v[152:155], v54
    s_waitcnt lgkmcnt(5)
    v_mfma_f32_16x16x32_bf16 v[8:11], v[80:83], v[208:211], v[8:11]
    ds_read_b128 v[220:223], v39
    s_waitcnt lgkmcnt(5)
    v_mfma_f32_16x16x32_bf16 v[12:15], v[144:147], v[208:211], v[12:15]
    ds_read_b128 v[156:159], v55
    s_waitcnt lgkmcnt(5)
    v_mfma_f32_16x16x32_bf16 v[8:11], v[84:87], v[212:215], v[8:11]
    ds_read_b128 v[224:227], v40
    s_waitcnt lgkmcnt(5)
    v_mfma_f32_16x16x32_bf16 v[12:15], v[148:151], v[212:215], v[12:15]
    ds_read_b128 v[160:163], v56
    s_waitcnt lgkmcnt(5)
    v_mfma_f32_16x16x32_bf16 v[8:11], v[88:91], v[216:219], v[8:11]
    ds_read_b128 v[228:231], v41
    s_waitcnt lgkmcnt(5)
    v_mfma_f32_16x16x32_bf16 v[12:15], v[152:155], v[216:219], v[12:15]
    ds_read_b128 v[164:167], v57
    s_waitcnt lgkmcnt(5)
    v_mfma_f32_16x16x32_bf16 v[8:11], v[92:95], v[220:223], v[8:11]
    ds_read_b128 v[232:235], v42
    s_waitcnt lgkmcnt(5)
    v_mfma_f32_16x16x32_bf16 v[12:15], v[156:159], v[220:223], v[12:15]
    ds_read_b128 v[168:171], v58
    s_waitcnt lgkmcnt(5)
    v_mfma_f32_16x16x32_bf16 v[8:11], v[96:99], v[224:227], v[8:11]
    ds_read_b128 v[236:239], v43
    s_waitcnt lgkmcnt(5)
    v_mfma_f32_16x16x32_bf16 v[12:15], v[160:163], v[224:227], v[12:15]
    ds_read_b128 v[172:175], v59
    s_waitcnt lgkmcnt(5)
    v_mfma_f32_16x16x32_bf16 v[8:11], v[100:103], v[228:231], v[8:11]
    ds_read_b128 v[240:243], v44
    s_waitcnt lgkmcnt(5)
    v_mfma_f32_16x16x32_bf16 v[12:15], v[164:167], v[228:231], v[12:15]
    ds_read_b128 v[176:179], v60
    s_waitcnt lgkmcnt(5)
    v_mfma_f32_16x16x32_bf16 v[8:11], v[104:107], v[232:235], v[8:11]
    ds_read_b128 v[244:247], v45
    s_waitcnt lgkmcnt(5)
    v_mfma_f32_16x16x32_bf16 v[12:15], v[168:171], v[232:235], v[12:15]
    ds_read_b128 v[180:183], v61
    s_waitcnt lgkmcnt(5)
    v_mfma_f32_16x16x32_bf16 v[8:11], v[108:111], v[236:239], v[8:11]
    ds_read_b128 v[248:251], v46
    s_waitcnt lgkmcnt(5)
    v_mfma_f32_16x16x32_bf16 v[12:15], v[172:175], v[236:239], v[12:15]
    ds_read_b128 v[184:187], v62
    s_waitcnt lgkmcnt(5)
    v_mfma_f32_16x16x32_bf16 v[8:11], v[112:115], v[240:243], v[8:11]
    ds_read_b128 v[252:255], v47
    s_waitcnt lgkmcnt(5)
    v_mfma_f32_16x16x32_bf16 v[12:15], v[176:179], v[240:243], v[12:15]
    ds_read_b128 v[188:191], v63
    s_waitcnt lgkmcnt(5)
    v_mfma_f32_16x16x32_bf16 v[8:11], v[116:119], v[244:247], v[8:11]
    s_waitcnt lgkmcnt(4)
    v_mfma_f32_16x16x32_bf16 v[12:15], v[180:183], v[244:247], v[12:15]
    s_waitcnt lgkmcnt(3)
    v_mfma_f32_16x16x32_bf16 v[8:11], v[120:123], v[248:251], v[8:11]
    s_waitcnt lgkmcnt(2)
    v_mfma_f32_16x16x32_bf16 v[12:15], v[184:187], v[248:251], v[12:15]
    s_waitcnt lgkmcnt(1)
    v_mfma_f32_16x16x32_bf16 v[8:11], v[124:127], v[252:255], v[8:11]
    s_waitcnt lgkmcnt(0)
    v_mfma_f32_16x16x32_bf16 v[12:15], v[188:191], v[252:255], v[12:15]
    s_nop 5
    v_max3_f32 v4, v8, v9, v10
    s_nop 0
    v_max3_f32 v5, v12, v13, v14
    v_max3_f32 v4, v4, v11, v15
    v_max_f32 v4, v4, v5
    ds_max_f32 v29, v4
    s_waitcnt lgkmcnt(0)
    s_barrier
    ds_read_b32 v16, v29
    s_waitcnt lgkmcnt(0)
    v_sub_f32 v8, v8, v16
    v_sub_f32 v9, v9, v16
    v_sub_f32 v10, v10, v16
    v_sub_f32 v11, v11, v16
    v_sub_f32 v12, v12, v16
    v_sub_f32 v13, v13, v16
    v_sub_f32 v14, v14, v16
    v_sub_f32 v15, v15, v16
    v_exp_f32 v8, v8
    v_exp_f32 v9, v9
    v_exp_f32 v10, v10
    v_exp_f32 v11, v11
    v_exp_f32 v12, v12
    v_exp_f32 v13, v13
    v_exp_f32 v14, v14
    v_exp_f32 v15, v15
    v_cvt_pk_bf16_f32 v4, v8, v9
    v_cvt_pk_bf16_f32 v5, v10, v11
    v_cvt_pk_bf16_f32 v6, v12, v13
    v_cvt_pk_bf16_f32 v7, v14, v15
    ds_write_b128 v30, v[4:7]
    v_pk_add_f32 v[8:9], v[8:9], v[10:11]
    v_pk_add_f32 v[12:13], v[12:13], v[14:15]
    v_pk_add_f32 v[8:9], v[8:9], v[12:13]
    v_add_f32 v8, v8, v9
    ds_write_b32 v31, v8
    s_waitcnt lgkmcnt(0)
    s_barrier
    s_cmp_eq_u32 s3, 0
    s_cbranch_scc0 L_s4
    s_setprio 3
    ds_read_b32 v8, v31 offset:0
    ds_read_b32 v9, v31 offset:256
    ds_read_b32 v10, v31 offset:512
    ds_read_b32 v11, v31 offset:768
    s_waitcnt lgkmcnt(0)
    v_add_f32 v8, v8, v9
    v_add_f32 v10, v10, v11
    v_add_f32 v17, v8, v10
    v_mov_b32 v8, v17
    s_nop 1
    v_permlane16_swap_b32 v17, v8
    v_add_f32 v17, v17, v8
    v_mov_b32 v8, v17
    s_nop 1
    v_permlane32_swap_b32 v17, v8
    v_add_f32 v17, v17, v8
    global_store_dwordx4 v22, v[16:19], s[30:31] sc1
    s_setprio 0
L_s4:
    v_and_b32 v4, 1, v1
    v_lshlrev_b32 v4, 4, v4
    v_mov_b32 v5, 0xffff
    v_lshlrev_b32 v4, v4, v5
    v_lshrrev_b32 v5, 1, v1
    v_cmp_eq_u32 vcc, 0, v5
    s_nop 1
    v_cndmask_b32 v20, 0, v4, vcc
    v_cmp_eq_u32 vcc, 1, v5
    s_nop 1
    v_cndmask_b32 v21, 0, v4, vcc
    v_cmp_eq_u32 vcc, 2, v5
    s_nop 1
    v_cndmask_b32 v22, 0, v4, vcc
    v_cmp_eq_u32 vcc, 3, v5
    s_nop 1
    v_cndmask_b32 v23, 0, v4, vcc
    v_and_b32 v4, 3, v0
    v_mul_u32_u24 v4, 0x35, v4
    v_xor_b32 v4, s6, v4
    v_bfe_u32 v24, v4, 0, 2
    v_mul_u32_u24 v24, 0x8001, v24
    v_and_b32 v24, 0x10001, v24
    v_bfe_u32 v25, v4, 2, 2
    v_mul_u32_u24 v25, 0x8001, v25
    v_and_b32 v25, 0x10001, v25
    v_bfe_u32 v26, v4, 4, 2
    v_mul_u32_u24 v26, 0x8001, v26
    v_and_b32 v26, 0x10001, v26
    v_bfe_u32 v27, v4, 6, 2
    v_mul_u32_u24 v27, 0x8001, v27
    v_and_b32 v27, 0x10001, v27
    s_lshl_b32 s7, s3, 4
    s_xor_b32 s7, s7, s5
    v_xor_b32 v48, s7, v1
    s_lshl_b32 s7, s32, 4
    s_lshl_b32 s34, s33, 15
    s_add_u32 s7, s7, s34
    s_add_u32 s7, s7, 786432
    v_lshl_add_u32 v48, v48, 9, s7
    s_lshl_b32 s7, s36, 14
    s_lshl_b32 s34, s3, 12
    s_add_u32 s7, s7, s34
    s_add_u32 s7, s7, 1048576
    v_lshl_add_u32 v49, v0, 4, s7
    s_lshl_b32 s7, s3, 7
    s_add_u32 s7, s7, 135168
    v_lshl_add_u32 v50, v1, 3, s7
    v_lshl_add_u32 v51, v2, 3, s7
    v_lshlrev_b32 v52, 3, v0
    v_add_u32 v52, 135168, v52
    s_mul_i32 s7, s3, 288
    s_add_u32 s7, s7, 131072
    v_lshl_add_u32 v53, v1, 4, s7
    v_lshl_add_u32 v53, v2, 3, v53
    v_and_b32 v54, 3, v0
    v_mul_u32_u24 v54, 288, v54
    v_lshl_add_u32 v54, v2, 4, v54
    v_add_u32 v54, 131072, v54
    s_lshl_b32 s7, s36, 8
    s_lshl_b32 s34, s3, 6
    s_add_u32 s7, s7, s34
    s_add_u32 s7, s7, 163840
    v_lshl_add_u32 v55, v0, 4, s7
    v_bfe_u32 v4, v0, 2, 2
    v_and_b32 v5, 1, v2
    v_lshl_or_b32 v61, v4, 1, v5
    s_lshl_b32 s7, s3, 1
    v_xor_b32 v61, s7, v61
    v_lshlrev_b32 v61, 5, v61
    v_and_b32 v5, 3, v0
    v_lshl_add_u32 v61, v5, 3, v61
    v_lshl_add_u32 v4, v4, 4, v2
    v_lshl_add_u32 v61, v4, 8, v61
    v_xor_b32 v62, 32, v61
    s_lshl_b32 s7, s36, 7
    s_add_u32 s7, s7, 442368
    v_mov_b32 v63, s7
    s_mov_b64 exec, 0xffff
    s_barrier
L_ml_poll:
    global_load_dwordx3 v[8:10], v48, s[30:31] sc1
    s_sub_u32 s35, s35, 1
    s_cbranch_scc1 L_end
    s_waitcnt vmcnt(0)
    v_cmp_ne_u32 vcc, s6, v10
    s_cbranch_vccnz L_ml_poll
    s_mov_b64 exec, -1
    global_load_dwordx4 v[192:195], v49, s[30:31] offset:0 sc1
    global_load_dwordx4 v[196:199], v49, s[30:31] offset:1024 sc1
    global_load_dwordx4 v[200:203], v49, s[30:31] offset:2048 sc1
    global_load_dwordx4 v[204:207], v49, s[30:31] offset:3072 sc1
    s_mov_b64 exec, 0xffff
    ds_write_b64 v50, v[8:9]
    s_mov_b64 exec, -1
    s_waitcnt lgkmcnt(0)
    s_barrier
    ds_read_b64 v[8:9], v52
    ds_read_b32 v12, v51 offset:0
    ds_read_b32 v13, v51 offset:32
    ds_read_b32 v14, v51 offset:64
    ds_read_b32 v15, v51 offset:96
    ds_read_b64_tr_b16 v[64:65], v61 offset:0
    ds_read_b64_tr_b16 v[66:67], v61 offset:16384
    ds_read_b64_tr_b16 v[68:69], v61 offset:1024
    ds_read_b64_tr_b16 v[70:71], v61 offset:17408
    ds_read_b64_tr_b16 v[72:73], v61 offset:2048
    ds_read_b64_tr_b16 v[74:75], v61 offset:18432
    ds_read_b64_tr_b16 v[76:77], v61 offset:3072
    ds_read_b64_tr_b16 v[78:79], v61 offset:19456
    ds_read_b64_tr_b16 v[80:81], v62 offset:0
    ds_read_b64_tr_b16 v[82:83], v62 offset:16384
    ds_read_b64_tr_b16 v[84:85], v62 offset:1024
    ds_read_b64_tr_b16 v[86:87], v62 offset:17408
    ds_read_b64_tr_b16 v[88:89], v62 offset:2048
    ds_read_b64_tr_b16 v[90:91], v62 offset:18432
    ds_read_b64_tr_b16 v[92:93], v62 offset:3072
    ds_read_b64_tr_b16 v[94:95], v62 offset:19456
    s_waitcnt lgkmcnt(15)
    v_mov_b32 v10, v8
    s_nop 1
    v_max_f32_dpp v10, v10, v10 quad_perm:[1,0,3,2] row_mask:0xf bank_mask:0xf
    s_nop 1
    v_max_f32_dpp v10, v10, v10 quad_perm:[2,3,0,1] row_mask:0xf bank_mask:0xf
    s_nop 1
    v_max_f32_dpp v10, v10, v10 row_half_mirror row_mask:0xf bank_mask:0xf
    s_nop 1
    v_max_f32_dpp v10, v10, v10 row_mirror row_mask:0xf bank_mask:0xf
    v_mov_b32 v11, v10
    s_nop 1
    v_permlane16_swap_b32 v10, v11
    v_max_f32 v10, v10, v11
    v_mov_b32 v11, v10
    s_nop 1
    v_permlane32_swap_b32 v10, v11
    v_max_f32 v10, v10, v11
    v_sub_f32 v8, v8, v10
    v_sub_f32 v12, v12, v10
    v_sub_f32 v13, v13, v10
    v_sub_f32 v14, v14, v10
    v_sub_f32 v15, v15, v10
    v_exp_f32 v8, v8
    v_exp_f32 v12, v12
    v_exp_f32 v13, v13
    v_exp_f32 v14, v14
    v_exp_f32 v15, v15
    v_cvt_pk_bf16_f32 v8, v8, v8
    v_cvt_pk_bf16_f32 v12, v12, v12
    v_cvt_pk_bf16_f32 v13, v13, v13
    v_cvt_pk_bf16_f32 v14, v14, v14
    v_cvt_pk_bf16_f32 v15, v15, v15
    v_and_b32 v8, 0xffff0000, v8
    v_mul_f32 v9, v9, v8
    v_and_b32 v208, v12, v20
    v_and_b32 v209, v12, v21
    v_and_b32 v210, v12, v22
    v_and_b32 v211, v12, v23
    v_and_b32 v212, v13, v20
    v_and_b32 v213, v13, v21
    v_and_b32 v214, v13, v22
    v_and_b32 v215, v13, v23
    v_and_b32 v216, v14, v20
    v_and_b32 v217, v14, v21
    v_and_b32 v218, v14, v22
    v_and_b32 v219, v14, v23
    v_and_b32 v220, v15, v20
    v_and_b32 v221, v15, v21
    v_and_b32 v222, v15, v22
    v_and_b32 v223, v15, v23
    v_add_f32_dpp v9, v9, v9 quad_perm:[1,0,3,2] row_mask:0xf bank_mask:0xf
    s_nop 1
    v_add_f32_dpp v9, v9, v9 quad_perm:[2,3,0,1] row_mask:0xf bank_mask:0xf
    s_nop 1
    v_add_f32_dpp v9, v9, v9 row_half_mirror row_mask:0xf bank_mask:0xf
    s_nop 1
    v_add_f32_dpp v9, v9, v9 row_mirror row_mask:0xf bank_mask:0xf
    s_branch L_c_chk
L_c_again:
    s_sub_u32 s35, s35, 1
    s_cbranch_scc1 L_end
    global_load_dwordx4 v[192:195], v49, s[30:31] offset:0 sc1
    global_load_dwordx4 v[196:199], v49, s[30:31] offset:1024 sc1
    global_load_dwordx4 v[200:203], v49, s[30:31] offset:2048 sc1
    global_load_dwordx4 v[204:207], v49, s[30:31] offset:3072 sc1
L_c_chk:
    s_waitcnt vmcnt(3)
    v_mfma_f32_16x16x32_bf16 v[224:227], v[208:211], v[192:195], 0
    v_xor_b32 v11, v192, v24
    v_bitop3_b32 v11, v11, v193, v25 bitop3:0xf6
    v_bitop3_b32 v11, v11, v194, v26 bitop3:0xf6
    v_bitop3_b32 v11, v11, v195, v27 bitop3:0xf6
    s_waitcnt vmcnt(2)
    v_mfma_f32_16x16x32_bf16 v[224:227], v[212:215], v[196:199], v[224:227]
    v_bitop3_b32 v11, v11, v196, v24 bitop3:0xf6
    v_bitop3_b32 v11, v11, v197, v25 bitop3:0xf6
    v_bitop3_b32 v11, v11, v198, v26 bitop3:0xf6
    v_bitop3_b32 v11, v11, v199, v27 bitop3:0xf6
    s_waitcnt vmcnt(1)
    v_mfma_f32_16x16x32_bf16 v[224:227], v[216:219], v[200:203], v[224:227]
    v_bitop3_b32 v11, v11, v200, v24 bitop3:0xf6
    v_bitop3_b32 v11, v11, v201, v25 bitop3:0xf6
    v_bitop3_b32 v11, v11, v202, v26 bitop3:0xf6
    v_bitop3_b32 v11, v11, v203, v27 bitop3:0xf6
    s_waitcnt vmcnt(0)
    v_mfma_f32_16x16x32_bf16 v[224:227], v[220:223], v[204:207], v[224:227]
    v_bitop3_b32 v11, v11, v204, v24 bitop3:0xf6
    v_bitop3_b32 v11, v11, v205, v25 bitop3:0xf6
    v_bitop3_b32 v11, v11, v206, v26 bitop3:0xf6
    v_bitop3_b32 v11, v11, v207, v27 bitop3:0xf6
    v_and_b32 v11, 0x10001, v11
    v_cmp_ne_u32 vcc, 0, v11
    s_cbranch_vccnz L_c_again
    s_mov_b32 exec_hi, 0
    v_cvt_pk_bf16_f32 v224, v224, v225
    v_cvt_pk_bf16_f32 v225, v226, v227
    ds_write_b64 v53, v[224:225]
    s_mov_b32 exec_hi, -1
    s_cmp_eq_u32 s3, 0
    s_cbranch_scc0 L_no_hd
    s_mov_b64 exec, 1
    global_store_dword v63, v18, s[30:31] sc1
    s_mov_b64 exec, -1
L_no_hd:
    s_waitcnt lgkmcnt(0)
    s_barrier
    ds_read_b128 v[192:195], v54 offset:0
    ds_read_b128 v[196:199], v54 offset:64
    ds_read_b128 v[200:203], v54 offset:128
    ds_read_b128 v[204:207], v54 offset:192
    v_mov_b32 v11, v9
    s_nop 1
    v_permlane16_swap_b32 v9, v11
    v_add_f32 v9, v9, v11
    v_mov_b32 v11, v9
    s_nop 1
    v_permlane32_swap_b32 v9, v11
    v_add_f32 v9, v9, v11
    v_rcp_f32 v9, v9
    s_waitcnt lgkmcnt(3)
    v_mfma_f32_16x16x32_bf16 v[224:227], v[192:195], v[64:67], 0
    v_mfma_f32_16x16x32_bf16 v[228:231], v[192:195], v[80:83], 0
    s_waitcnt lgkmcnt(2)
    v_mfma_f32_16x16x32_bf16 v[224:227], v[196:199], v[68:71], v[224:227]
    v_mfma_f32_16x16x32_bf16 v[228:231], v[196:199], v[84:87], v[228:231]
    s_waitcnt lgkmcnt(1)
    v_mfma_f32_16x16x32_bf16 v[224:227], v[200:203], v[72:75], v[224:227]
    v_mfma_f32_16x16x32_bf16 v[228:231], v[200:203], v[88:91], v[228:231]
    s_waitcnt lgkmcnt(0)
    v_mfma_f32_16x16x32_bf16 v[224:227], v[204:207], v[76:79], v[224:227]
    v_mfma_f32_16x16x32_bf16 v[228:231], v[204:207], v[92:95], v[228:231]
    s_nop 6
    v_pk_add_f32 v[224:225], v[224:225], v[226:227]
    v_pk_add_f32 v[228:229], v[228:229], v[230:231]
    v_add_f32 v224, v224, v225
    v_add_f32 v228, v228, v229
    v_mul_f32 v224, v224, v9
    v_mul_f32 v228, v228, v9
    v_cvt_pk_bf16_f32 v228, v224, v228
    s_nop 1
    v_mov_b32_dpp v229, v228 row_shl:4 row_mask:0xf bank_mask:0xf
    v_mov_b32_dpp v230, v228 row_shl:8 row_mask:0xf bank_mask:0xf
    v_mov_b32_dpp v231, v228 row_shl:12 row_mask:0xf bank_mask:0xf
    s_mov_b64 exec, 0xf
    global_store_dwordx4 v55, v[228:231], s[30:31] sc1
    s_mov_b64 exec, -1
    s_branch L_ffn
L_pv:
    s_mov_b32 s35, 262144
    v_lshrrev_b32 v5, 2, v0
    v_lshlrev_b32 v6, 1, v5
    v_and_b32 v6, 15, v6
    v_lshrrev_b32 v7, 3, v5
    v_or_b32 v6, v6, v7
    v_bfe_u32 v7, v0, 1, 1
    v_xor_b32 v6, v6, v7
    v_lshlrev_b32 v6, 4, v6
    v_and_b32 v7, 1, v0
    v_lshl_add_u32 v6, v7, 3, v6
    v_lshl_add_u32 v6, v5, 10, v6
    s_lshl_b32 s7, s34, 8
    v_add_u32 v6, s7, v6
    v_xor_b32 v32, 0, v6
    v_xor_b32 v33, 32, v6
    v_xor_b32 v34, 64, v6
    v_xor_b32 v35, 96, v6
    v_xor_b32 v36, 128, v6
    v_xor_b32 v37, 160, v6
    v_xor_b32 v38, 192, v6
    v_xor_b32 v39, 224, v6
    s_lshl_b32 s7, s51, 20
    s_lshl_b32 s40, s34, 14
    s_add_u32 s7, s7, s40
    s_add_u32 s7, s7, 1048576
    v_lshl_add_u32 v5, v1, 4, s7
    v_lshl_add_u32 v5, v2, 18, v5
    v_lshlrev_b32 v6, 2, v2
    v_xor_b32 v6, s50, v6
    v_lshl_add_u32 v20, v6, 8, v5
    v_xor_b32 v21, 0x10100, v20
    v_xor_b32 v22, 0x20200, v20
    v_xor_b32 v23, 0x30300, v20
    v_lshlrev_b32 v57, 4, v0
    v_add_u32 v57, 147456, v57
    s_lshl_b32 s7, s33, 7
    s_lshl_b32 s40, s34, 2
    s_add_u32 s7, s7, s40
    v_add_u32 v4, s7, v2
    v_and_b32 v5, 1, v2
    v_lshlrev_b32 v5, 1, v5
    v_xor_b32 v5, v5, v1
    v_lshlrev_b32 v5, 4, v5
    v_lshl_add_u32 v4, v4, 13, v5
    s_lshl_b32 s7, s32, 8
    v_add_u32 v4, s7, v4
    s_lshl_b32 s40, s34, 10
    s_lshl_b32 s7, s32, 2
    s_add_u32 s7, s7, s33
    s_lshl_b32 s7, s7, 7
    s_add_u32 s7, s7, 442368
    v_mov_b32 v58, s7
    v_add_u32 v40, 0, v4
    v_xor_b32 v40, 0, v40
    v_add_u32 v41, 131072, v4
    v_xor_b32 v41, 64, v41
    v_add_u32 v42, 262144, v4
    v_xor_b32 v42, 128, v42
    v_add_u32 v43, 393216, v4
    v_xor_b32 v43, 192, v43
    v_add_u32 v44, 524288, v4
    v_xor_b32 v44, 0, v44
    v_add_u32 v45, 655360, v4
    v_xor_b32 v45, 64, v45
    v_add_u32 v46, 786432, v4
    v_xor_b32 v46, 128, v46
    v_add_u32 v47, 917504, v4
    v_xor_b32 v47, 192, v47
    s_waitcnt lgkmcnt(0)
    s_mul_i32 s6, s6, 0x0019660d
    s_add_u32 s6, s6, 0x3c6ef35f
    s_bitset0_b32 s6, 31
    v_and_b32 v4, 3, v0
    v_mul_u32_u24 v4, 0x35, v4
    v_xor_b32 v4, s6, v4
    v_bfe_u32 v12, v4, 0, 2
    v_mul_u32_u24 v12, 0x8001, v12
    v_and_b32 v12, 0x10001, v12
    v_bfe_u32 v13, v4, 2, 2
    v_mul_u32_u24 v13, 0x8001, v13
    v_and_b32 v13, 0x10001, v13
    v_bfe_u32 v14, v4, 4, 2
    v_mul_u32_u24 v14, 0x8001, v14
    v_and_b32 v14, 0x10001, v14
    v_bfe_u32 v15, v4, 6, 2
    v_mul_u32_u24 v15, 0x8001, v15
    v_and_b32 v15, 0x10001, v15
    v_mov_b32 v59, s6
    s_mov_b32 s46, 0xfffefffe
    s_barrier
    s_barrier
    s_add_u32 m0, m0, 4096
    s_nop 0
    global_load_lds_dwordx4 v28, s[44:45] offset:0
    global_load_lds_dwordx4 v29, s[44:45] offset:1024
    global_load_lds_dwordx4 v30, s[44:45] offset:2048
    global_load_lds_dwordx4 v31, s[44:45] offset:3072
    s_xor_b32 m0, s38, 32768
    s_lshl_b32 s44, m0, 6
    s_add_u32 s44, s42, s44
    s_addc_u32 s45, s43, 0
    global_load_lds_dwordx4 v24, s[44:45] offset:0 nt
    global_load_lds_dwordx4 v25, s[44:45] offset:1024 nt
    global_load_lds_dwordx4 v26, s[44:45] offset:2048 nt
    global_load_lds_dwordx4 v27, s[44:45] offset:3072 nt
    s_add_u32 m0, m0, 4096
    s_nop 0
    global_load_lds_dwordx4 v28, s[44:45] offset:0 nt
    global_load_lds_dwordx4 v29, s[44:45] offset:1024 nt
    global_load_lds_dwordx4 v30, s[44:45] offset:2048 nt
    global_load_lds_dwordx4 v31, s[44:45] offset:3072 nt
    s_xor_b32 m0, s38, 65536
    s_lshl_b32 s44, m0, 6
    s_add_u32 s44, s42, s44
    s_addc_u32 s45, s43, 0
    global_load_lds_dwordx4 v24, s[44:45] offset:0
    global_load_lds_dwordx4 v25, s[44:45] offset:1024
    global_load_lds_dwordx4 v26, s[44:45] offset:2048
    global_load_lds_dwordx4 v27, s[44:45] offset:3072
    s_add_u32 m0, m0, 4096
    s_nop 0
    global_load_lds_dwordx4 v28, s[44:45] offset:0
    global_load_lds_dwordx4 v29, s[44:45] offset:1024
    global_load_lds_dwordx4 v30, s[44:45] offset:2048
    global_load_lds_dwordx4 v31, s[44:45] offset:3072
    s_waitcnt vmcnt(8)
    s_barrier
    s_xor_b32 m0, s38, 98304
    s_lshl_b32 s44, m0, 6
    s_add_u32 s44, s42, s44
    s_addc_u32 s45, s43, 0
    global_load_lds_dwordx4 v24, s[44:45] offset:0 nt
    global_load_lds_dwordx4 v25, s[44:45] offset:1024 nt
    global_load_lds_dwordx4 v26, s[44:45] offset:2048 nt
    global_load_lds_dwordx4 v27, s[44:45] offset:3072 nt
    s_add_u32 m0, m0, 4096
    s_nop 0
    global_load_lds_dwordx4 v28, s[44:45] offset:0 nt
    global_load_lds_dwordx4 v29, s[44:45] offset:1024 nt
    global_load_lds_dwordx4 v30, s[44:45] offset:2048 nt
    global_load_lds_dwordx4 v31, s[44:45] offset:3072 nt
    ds_read_b64_tr_b16 v[64:65], v32 offset:0
    ds_read_b64_tr_b16 v[68:69], v32 offset:16384
    ds_read_b64_tr_b16 v[72:73], v32 offset:32768
    ds_read_b64_tr_b16 v[76:77], v32 offset:49152
    ds_read_b64_tr_b16 v[80:81], v33 offset:0
    ds_read_b64_tr_b16 v[84:85], v33 offset:16384
    ds_read_b64_tr_b16 v[88:89], v33 offset:32768
    ds_read_b64_tr_b16 v[92:93], v33 offset:49152
    ds_read_b64_tr_b16 v[96:97], v34 offset:0
    ds_read_b64_tr_b16 v[100:101], v34 offset:16384
    ds_read_b64_tr_b16 v[104:105], v34 offset:32768
    ds_read_b64_tr_b16 v[108:109], v34 offset:49152
    ds_read_b64_tr_b16 v[112:113], v35 offset:0
    ds_read_b64_tr_b16 v[116:117], v35 offset:16384
    ds_read_b64_tr_b16 v[120:121], v35 offset:32768
    ds_read_b64_tr_b16 v[124:125], v35 offset:49152
    ds_read_b64_tr_b16 v[128:129], v36 offset:0
    ds_read_b64_tr_b16 v[132:133], v36 offset:16384
    ds_read_b64_tr_b16 v[136:137], v36 offset:32768
    ds_read_b64_tr_b16 v[140:141], v36 offset:49152
    ds_read_b64_tr_b16 v[144:145], v37 offset:0
    ds_read_b64_tr_b16 v[148:149], v37 offset:16384
    ds_read_b64_tr_b16 v[152:153], v37 offset:32768
    ds_read_b64_tr_b16 v[156:157], v37 offset:49152
    ds_read_b64_tr_b16 v[160:161], v38 offset:0
    ds_read_b64_tr_b16 v[164:165], v38 offset:16384
    ds_read_b64_tr_b16 v[168:169], v38 offset:32768
    ds_read_b64_tr_b16 v[172:173], v38 offset:49152
    ds_read_b64_tr_b16 v[176:177], v39 offset:0
    ds_read_b64_tr_b16 v[180:181], v39 offset:16384
    ds_read_b64_tr_b16 v[184:185], v39 offset:32768
    ds_read_b64_tr_b16 v[188:189], v39 offset:49152
    v_add_u32 v32, 0x10000, v32
    v_add_u32 v33, 0x10000, v33
    v_add_u32 v34, 0x10000, v34
    v_add_u32 v35, 0x10000, v35
    v_add_u32 v36, 0x10000, v36
    v_add_u32 v37, 0x10000, v37
    v_add_u32 v38, 0x10000, v38
    v_add_u32 v39, 0x10000, v39
    s_waitcnt vmcnt(0) lgkmcnt(0)
    s_barrier
    s_add_u32 m0, s40, 0
    s_nop 0
    global_load_lds_dwordx4 v40, s[16:17] nt
    s_add_u32 m0, s40, 4096
    s_nop 0
    global_load_lds_dwordx4 v41, s[16:17] nt
    s_add_u32 m0, s40, 8192
    s_nop 0
    global_load_lds_dwordx4 v42, s[16:17] nt
    s_add_u32 m0, s40, 12288
    s_nop 0
    global_load_lds_dwordx4 v43, s[16:17] nt
    s_add_u32 m0, s40, 16384
    s_nop 0
    global_load_lds_dwordx4 v44, s[16:17] nt
    s_add_u32 m0, s40, 20480
    s_nop 0
    global_load_lds_dwordx4 v45, s[16:17] nt
    s_add_u32 m0, s40, 24576
    s_nop 0
    global_load_lds_dwordx4 v46, s[16:17] nt
    s_add_u32 m0, s40, 28672
    s_nop 0
    global_load_lds_dwordx4 v47, s[16:17] nt
    s_barrier
    ds_read_b64_tr_b16 v[66:67], v32 offset:0
    ds_read_b64_tr_b16 v[70:71], v32 offset:16384
    ds_read_b64_tr_b16 v[74:75], v32 offset:32768
    ds_read_b64_tr_b16 v[78:79], v32 offset:49152
    ds_read_b64_tr_b16 v[82:83], v33 offset:0
    ds_read_b64_tr_b16 v[86:87], v33 offset:16384
    ds_read_b64_tr_b16 v[90:91], v33 offset:32768
    ds_read_b64_tr_b16 v[94:95], v33 offset:49152
    ds_read_b64_tr_b16 v[98:99], v34 offset:0
    ds_read_b64_tr_b16 v[102:103], v34 offset:16384
    ds_read_b64_tr_b16 v[106:107], v34 offset:32768
    ds_read_b64_tr_b16 v[110:111], v34 offset:49152
    ds_read_b64_tr_b16 v[114:115], v35 offset:0
    ds_read_b64_tr_b16 v[118:119], v35 offset:16384
    ds_read_b64_tr_b16 v[122:123], v35 offset:32768
    ds_read_b64_tr_b16 v[126:127], v35 offset:49152
    ds_read_b64_tr_b16 v[130:131], v36 offset:0
    ds_read_b64_tr_b16 v[134:135], v36 offset:16384
    ds_read_b64_tr_b16 v[138:139], v36 offset:32768
    ds_read_b64_tr_b16 v[142:143], v36 offset:49152
    ds_read_b64_tr_b16 v[146:147], v37 offset:0
    ds_read_b64_tr_b16 v[150:151], v37 offset:16384
    ds_read_b64_tr_b16 v[154:155], v37 offset:32768
    ds_read_b64_tr_b16 v[158:159], v37 offset:49152
    ds_read_b64_tr_b16 v[162:163], v38 offset:0
    ds_read_b64_tr_b16 v[166:167], v38 offset:16384
    ds_read_b64_tr_b16 v[170:171], v38 offset:32768
    ds_read_b64_tr_b16 v[174:175], v38 offset:49152
    ds_read_b64_tr_b16 v[178:179], v39 offset:0
    ds_read_b64_tr_b16 v[182:183], v39 offset:16384
    ds_read_b64_tr_b16 v[186:187], v39 offset:32768
    ds_read_b64_tr_b16 v[190:191], v39 offset:49152
    s_setprio 2
    s_waitcnt lgkmcnt(0)
    s_barrier
    ds_read_b128 v[192:195], v57 offset:0
    ds_read_b128 v[196:199], v57 offset:1024
    ds_read_b128 v[200:203], v57 offset:2048
    ds_read_b128 v[204:207], v57 offset:3072
    s_waitcnt lgkmcnt(3)
    v_mfma_f32_16x16x32_bf16 v[208:211], v[192:195], v[64:67], 0
    s_waitcnt lgkmcnt(2)
    v_mfma_f32_16x16x32_bf16 v[208:211], v[196:199], v[68:71], v[208:211]
    s_waitcnt lgkmcnt(1)
    v_mfma_f32_16x16x32_bf16 v[208:211], v[200:203], v[72:75], v[208:211]
    s_waitcnt lgkmcnt(0)
    v_mfma_f32_16x16x32_bf16 v[208:211], v[204:207], v[76:79], v[208:211]
    v_mfma_f32_16x16x32_bf16 v[212:215], v[192:195], v[80:83], 0
    v_mfma_f32_16x16x32_bf16 v[212:215], v[196:199], v[84:87], v[212:215]
    v_mfma_f32_16x16x32_bf16 v[212:215], v[200:203], v[88:91], v[212:215]
    v_mfma_f32_16x16x32_bf16 v[212:215], v[204:207], v[92:95], v[212:215]
    v_mfma_f32_16x16x32_bf16 v[216:219], v[192:195], v[96:99], 0
    v_mfma_f32_16x16x32_bf16 v[216:219], v[196:199], v[100:103], v[216:219]
    v_mfma_f32_16x16x32_bf16 v[216:219], v[200:203], v[104:107], v[216:219]
    v_mfma_f32_16x16x32_bf16 v[216:219], v[204:207], v[108:111], v[216:219]
    v_mfma_f32_16x16x32_bf16 v[220:223], v[192:195], v[112:115], 0
    v_mfma_f32_16x16x32_bf16 v[220:223], v[196:199], v[116:119], v[220:223]
    v_mfma_f32_16x16x32_bf16 v[220:223], v[200:203], v[120:123], v[220:223]
    v_mfma_f32_16x16x32_bf16 v[220:223], v[204:207], v[124:127], v[220:223]
    v_mfma_f32_16x16x32_bf16 v[224:227], v[192:195], v[128:131], 0
    v_cvt_pk_bf16_f32 v240, v208, v212
    v_mfma_f32_16x16x32_bf16 v[224:227], v[196:199], v[132:135], v[224:227]
    v_cvt_pk_bf16_f32 v244, v209, v213
    v_mfma_f32_16x16x32_bf16 v[224:227], v[200:203], v[136:139], v[224:227]
    v_cvt_pk_bf16_f32 v248, v210, v214
    v_mfma_f32_16x16x32_bf16 v[224:227], v[204:207], v[140:143], v[224:227]
    v_cvt_pk_bf16_f32 v252, v211, v215
    v_mfma_f32_16x16x32_bf16 v[228:231], v[192:195], v[144:147], 0
    v_and_or_b32 v240, v240, s46, v12
    v_mfma_f32_16x16x32_bf16 v[228:231], v[196:199], v[148:151], v[228:231]
    v_and_or_b32 v244, v244, s46, v12
    v_mfma_f32_16x16x32_bf16 v[228:231], v[200:203], v[152:155], v[228:231]
    v_and_or_b32 v248, v248, s46, v12
    v_mfma_f32_16x16x32_bf16 v[228:231], v[204:207], v[156:159], v[228:231]
    v_and_or_b32 v252, v252, s46, v12
    v_mfma_f32_16x16x32_bf16 v[232:235], v[192:195], v[160:163], 0
    v_cvt_pk_bf16_f32 v241, v216, v220
    v_mfma_f32_16x16x32_bf16 v[232:235], v[196:199], v[164:167], v[232:235]
    v_cvt_pk_bf16_f32 v245, v217, v221
    v_mfma_f32_16x16x32_bf16 v[232:235], v[200:203], v[168:171], v[232:235]
    v_cvt_pk_bf16_f32 v249, v218, v222
    v_mfma_f32_16x16x32_bf16 v[232:235], v[204:207], v[172:175], v[232:235]
    v_cvt_pk_bf16_f32 v253, v219, v223
    v_mfma_f32_16x16x32_bf16 v[236:239], v[192:195], v[176:179], 0
    v_and_or_b32 v241, v241, s46, v13
    v_mfma_f32_16x16x32_bf16 v[236:239], v[196:199], v[180:183], v[236:239]
    v_and_or_b32 v245, v245, s46, v13
    v_mfma_f32_16x16x32_bf16 v[236:239], v[200:203], v[184:187], v[236:239]
    v_and_or_b32 v249, v249, s46, v13
    v_mfma_f32_16x16x32_bf16 v[236:239], v[204:207], v[188:191], v[236:239]
    v_and_or_b32 v253, v253, s46, v13
    v_cvt_pk_bf16_f32 v242, v224, v228
    v_cvt_pk_bf16_f32 v246, v225, v229
    v_cvt_pk_bf16_f32 v250, v226, v230
    v_cvt_pk_bf16_f32 v254, v227, v231
    v_and_or_b32 v242, v242, s46, v14
    v_and_or_b32 v246, v246, s46, v14
    v_and_or_b32 v250, v250, s46, v14
    v_and_or_b32 v254, v254, s46, v14
    v_cvt_pk_bf16_f32 v243, v232, v236
    v_and_or_b32 v243, v243, s46, v15
    global_store_dwordx4 v20, v[240:243], s[30:31] sc1
    v_cvt_pk_bf16_f32 v247, v233, v237
    v_and_or_b32 v247, v247, s46, v15
    global_store_dwordx4 v21, v[244:247], s[30:31] sc1
    v_cvt_pk_bf16_f32 v251, v234, v238
    v_and_or_b32 v251, v251, s46, v15
    global_store_dwordx4 v22, v[248:251], s[30:31] sc1
    v_cvt_pk_bf16_f32 v255, v235, v239
    v_and_or_b32 v255, v255, s46, v15
    global_store_dwordx4 v23, v[252:255], s[30:31] sc1
    s_setprio 0
    s_barrier
    s_waitcnt vmcnt(4)
L_ffn:
    s_mul_i32 s32, s4, 18
    s_add_u32 s32, s32, s5
    s_and_b32 s36, s3, 1
    s_cmp_lt_u32 s3, 4
    s_cbranch_scc0 L_ffn_ld
    s_barrier
    s_branch L_ffn_ld_done
L_ffn_ld:
    s_and_b32 s42, s3, 3
    v_lshrrev_b32 v4, 2, v0
    v_mul_u32_u24 v4, 9216, v4
    v_and_b32 v5, 1, v2
    v_lshlrev_b32 v5, 1, v5
    v_and_b32 v6, 3, v0
    v_xor_b32 v5, v5, v6
    v_lshl_add_u32 v4, v5, 4, v4
    s_lshl_b32 s7, s32, 6
    s_mul_i32 s34, s42, 147456
    s_add_u32 s7, s7, s34
    v_add_u32 v6, s7, v4
    v_lshrrev_b32 v4, 3, v0
    v_and_b32 v5, 6, v4
    v_and_b32 v7, 7, v0
    v_xor_b32 v5, v5, v7
    v_lshlrev_b32 v5, 4, v5
    s_lshl_b32 s7, s32, 5
    s_lshl_b32 s40, s42, 3
    s_add_u32 s7, s7, s40
    v_add_u32 v7, s7, v4
    v_mul_u32_u24 v7, 1152, v7
    v_add_u32 v7, v7, v5
    s_mul_i32 s40, s42, 9216
    s_add_u32 s40, s40, 69632
    s_lshl_b32 s41, s42, 10
    s_add_u32 s41, s41, 32768
    v_and_b32 v4, 31, v0
    v_lshlrev_b32 v4, 2, v4
    v_add_u32 v4, 152832, v4
    v_mov_b32 v5, 0
    ds_write_b32 v4, v5
    s_barrier
    s_cmp_eq_u32 s49, 0
    s_cbranch_scc1 L_ffn_g1
    s_barrier
    s_barrier
L_ffn_g1:
    s_add_u32 m0, s41, 0
    s_nop 0
    global_load_lds_dwordx4 v6, s[22:23]
    s_add_u32 m0, s41, 4096
    v_add_u32 v6, 589824, v6
    global_load_lds_dwordx4 v6, s[22:23]
    s_add_u32 m0, s41, 8192
    v_add_u32 v6, 589824, v6
    global_load_lds_dwordx4 v6, s[22:23]
    s_add_u32 m0, s41, 12288
    v_add_u32 v6, 589824, v6
    global_load_lds_dwordx4 v6, s[22:23]
    s_add_u32 m0, s41, 16384
    v_add_u32 v6, 589824, v6
    global_load_lds_dwordx4 v6, s[22:23]
    s_add_u32 m0, s41, 20480
    v_add_u32 v6, 589824, v6
    global_load_lds_dwordx4 v6, s[22:23]
    s_add_u32 m0, s41, 24576
    v_add_u32 v6, 589824, v6
    global_load_lds_dwordx4 v6, s[22:23]
    s_add_u32 m0, s41, 28672
    v_add_u32 v6, 589824, v6
    global_load_lds_dwordx4 v6, s[22:23]
    s_add_u32 m0, s41, 32768
    v_add_u32 v6, 589824, v6
    global_load_lds_dwordx4 v6, s[22:23]
    s_add_u32 m0, s40, 0
    s_nop 0
    global_load_lds_dwordx4 v7, s[24:25] offset:0 nt
    s_add_u32 m0, s40, 896
    s_nop 0
    global_load_lds_dwordx4 v7, s[24:25] offset:128 nt
    s_add_u32 m0, s40, 1792
    s_nop 0
    global_load_lds_dwordx4 v7, s[24:25] offset:256 nt
    s_add_u32 m0, s40, 2688
    s_nop 0
    global_load_lds_dwordx4 v7, s[24:25] offset:384 nt
    s_add_u32 m0, s40, 3584
    s_nop 0
    global_load_lds_dwordx4 v7, s[24:25] offset:512 nt
    s_add_u32 m0, s40, 4480
    s_nop 0
    global_load_lds_dwordx4 v7, s[24:25] offset:640 nt
    s_add_u32 m0, s40, 5376
    s_nop 0
    global_load_lds_dwordx4 v7, s[24:25] offset:768 nt
    s_add_u32 m0, s40, 6272
    s_nop 0
    global_load_lds_dwordx4 v7, s[24:25] offset:896 nt
    s_add_u32 m0, s40, 7168
    s_nop 0
    global_load_lds_dwordx4 v7, s[24:25] offset:1024 nt
L_ffn_ld_done:
    v_lshrrev_b32 v8, 2, v1
    v_lshlrev_b32 v8, 5, v8
    v_and_b32 v9, 3, v1
    v_lshl_add_u32 v8, v9, 2, v8
    v_and_b32 v9, 1, v2
    v_lshl_add_u32 v8, v9, 4, v8
    s_lshl_b32 s7, s3, 7
    v_add_u32 v8, s7, v8
    v_min_u32 v8, 572, v8
    v_lshlrev_b32 v8, 1, v8
    global_load_dwordx2 v[10:11], v8, s[8:9]
    v_and_b32 v4, 1, v2
    v_xor_b32 v4, s36, v4
    v_and_b32 v5, 3, v0
    v_lshlrev_b32 v5, 3, v5
    v_lshl_add_u32 v21, v4, 5, v5
    v_lshrrev_b32 v6, 2, v0
    v_lshl_add_u32 v21, v6, 6, v21
    s_lshr_b32 s34, s3, 1
    s_mul_i32 s7, s34, 18432
    s_add_u32 s7, s7, 32768
    v_add_u32 v21, s7, v21
    s_lshl_b32 s7, s3, 6
    s_add_u32 s7, s7, 152960
    v_lshl_add_u32 v30, v1, 2, s7
    s_mov_b32 s37, 0x3f803f80
    v_mov_b32 v60, s37
    v_mov_b32 v61, s37
    v_mov_b32 v62, s37
    v_mov_b32 v63, s37
    s_waitcnt vmcnt(10)
    s_barrier
    s_cmp_lt_u32 s3, 4
    s_cbranch_scc0 L_ffn_no_w1
    ds_read_b64_tr_b16 v[64:65], v21 offset:0
    ds_read_b64_tr_b16 v[66:67], v21 offset:1024
    ds_read_b64_tr_b16 v[68:69], v21 offset:2048
    ds_read_b64_tr_b16 v[70:71], v21 offset:3072
    ds_read_b64_tr_b16 v[72:73], v21 offset:4096
    ds_read_b64_tr_b16 v[74:75], v21 offset:5120
    ds_read_b64_tr_b16 v[76:77], v21 offset:6144
    ds_read_b64_tr_b16 v[78:79], v21 offset:7168
    ds_read_b64_tr_b16 v[80:81], v21 offset:8192
    ds_read_b64_tr_b16 v[82:83], v21 offset:9216
    ds_read_b64_tr_b16 v[84:85], v21 offset:10240
    ds_read_b64_tr_b16 v[86:87], v21 offset:11264
    ds_read_b64_tr_b16 v[88:89], v21 offset:12288
    ds_read_b64_tr_b16 v[90:91], v21 offset:13312
    ds_read_b64_tr_b16 v[92:93], v21 offset:14336
    ds_read_b64_tr_b16 v[94:95], v21 offset:15360
    ds_read_b64_tr_b16 v[96:97], v21 offset:16384
    ds_read_b64_tr_b16 v[98:99], v21 offset:17408
    s_waitcnt lgkmcnt(0)
    v_mfma_f32_16x16x32_bf16 v[52:55], v[60:63], v[64:67], 0
    v_mfma_f32_16x16x32_bf16 v[52:55], v[60:63], v[68:71], v[52:55]
    v_mfma_f32_16x16x32_bf16 v[52:55], v[60:63], v[72:75], v[52:55]
    v_mfma_f32_16x16x32_bf16 v[52:55], v[60:63], v[76:79], v[52:55]
    v_mfma_f32_16x16x32_bf16 v[52:55], v[60:63], v[80:83], v[52:55]
    v_mfma_f32_16x16x32_bf16 v[52:55], v[60:63], v[84:87], v[52:55]
    v_mfma_f32_16x16x32_bf16 v[52:55], v[60:63], v[88:91], v[52:55]
    v_mfma_f32_16x16x32_bf16 v[52:55], v[60:63], v[92:95], v[52:55]
    v_mfma_f32_16x16x32_bf16 v[52:55], v[60:63], v[96:99], v[52:55]
    s_nop 7
    ds_write_b32 v30, v52 offset:256
L_ffn_no_w1:
    v_and_b32 v13, 1, v1
    v_lshlrev_b32 v13, 4, v13
    v_mov_b32 v14, 0xffff
    v_lshlrev_b32 v13, v13, v14
    v_lshrrev_b32 v14, 1, v1
    v_cmp_eq_u32 vcc, 0, v14
    s_nop 1
    v_cndmask_b32 v16, 0, v13, vcc
    v_cmp_eq_u32 vcc, 1, v14
    s_nop 1
    v_cndmask_b32 v17, 0, v13, vcc
    v_cmp_eq_u32 vcc, 2, v14
    s_nop 1
    v_cndmask_b32 v18, 0, v13, vcc
    v_cmp_eq_u32 vcc, 3, v14
    s_nop 1
    v_cndmask_b32 v19, 0, v13, vcc
    v_and_b32 v16, s37, v16
    v_and_b32 v17, s37, v17
    v_and_b32 v18, s37, v18
    v_and_b32 v19, s37, v19
    v_bfe_u32 v4, v0, 2, 3
    v_and_b32 v6, 6, v4
    v_lshlrev_b32 v6, 4, v6
    v_xor_b32 v5, v5, v6
    s_lshl_b32 s7, s36, 6
    v_xor_b32 v5, s7, v5
    v_lshl_add_u32 v5, v4, 7, v5
    v_lshrrev_b32 v6, 5, v0
    v_mul_u32_u24 v6, 9216, v6
    s_lshl_b32 s7, s34, 10
    s_add_u32 s7, s7, 69632
    v_add3_u32 v23, v5, v6, s7
    v_xor_b32 v24, 32, v23
    s_lshl_b32 s7, s3, 8
    v_lshl_add_u32 v26, v1, 4, s7
    v_min_u32 v25, 1136, v26
    v_mul_u32_u24 v4, 1152, v2
    v_add_u32 v25, v25, v4
    v_add_u32 v25, 196608, v25
    v_add_u32 v33, 4608, v25
    v_lshl_add_u32 v26, v2, 3, v26
    v_add_u32 v26, 151680, v26
    s_mul_i32 s7, s34, 576
    s_add_u32 s7, s7, 151680
    v_lshl_add_u32 v27, v2, 4, s7
    v_lshlrev_b32 v28, 4, v0
    v_add_u32 v28, 151680, v28
    v_lshlrev_b32 v29, 2, v0
    v_add_u32 v29, 152704, v29
    v_bfe_u32 v4, v1, 2, 1
    v_lshlrev_b32 v4, 6, v4
    v_lshl_add_u32 v4, v2, 4, v4
    v_and_b32 v5, 3, v1
    v_lshl_add_u32 v4, v5, 2, v4
    v_add_u32 v31, 152960, v4
    v_mov_b32 v22, 153472
    s_mul_i32 s7, s32, 1152
    s_lshl_b32 s40, s3, 6
    s_add_u32 s7, s7, s40
    s_add_u32 s7, s7, 205824
    v_lshl_add_u32 v32, v2, 4, s7
    v_lshrrev_b32 v4, 1, v1
    v_mul_u32_u24 v4, 9, v4
    v_and_b32 v5, 1, v1
    s_lshl_b32 s7, s3, 1
    v_add_u32 v5, s7, v5
    v_min_u32 v5, 8, v5
    v_add_u32 v4, v4, v5
    s_mul_i32 s7, s4, 9216
    s_add_u32 s7, s7, 655360
    v_lshl_add_u32 v34, v4, 7, s7
    s_lshl_b32 s7, s32, 7
    s_add_u32 s7, s7, 409600
    v_mov_b32 v36, s7
    v_mov_b32 v37, s6
    s_mov_b32 s38, -1
    s_cmp_eq_u32 s3, 4
    s_cselect_b32 s38, 0x00ff00ff, s38
    s_mov_b32 s40, 0x00010001
    s_mov_b32 s41, 0x00010001
    s_waitcnt vmcnt(0)
    s_barrier
    ds_read_b64_tr_b16 v[208:209], v23 offset:0
    ds_read_b64_tr_b16 v[210:211], v23 offset:18432
    ds_read_b64_tr_b16 v[212:213], v24 offset:0
    ds_read_b64_tr_b16 v[214:215], v24 offset:18432
    ds_read_b64_tr_b16 v[216:217], v23 offset:4096
    ds_read_b64_tr_b16 v[218:219], v23 offset:22528
    ds_read_b64_tr_b16 v[220:221], v24 offset:4096
    ds_read_b64_tr_b16 v[222:223], v24 offset:22528
    s_cmp_lt_u32 s3, 2
    s_cbranch_scc0 L_ffn_no3
    ds_read_b64_tr_b16 v[224:225], v23 offset:8192
    ds_read_b64_tr_b16 v[226:227], v23 offset:26624
    ds_read_b64_tr_b16 v[228:229], v24 offset:8192
    ds_read_b64_tr_b16 v[230:231], v24 offset:26624
L_ffn_no3:
    v_lshlrev_b32 v56, 16, v10
    v_and_b32 v57, 0xffff0000, v10
    v_lshlrev_b32 v58, 16, v11
    v_and_b32 v59, 0xffff0000, v11
    s_cmp_lt_u32 s3, 5
    s_cbranch_scc0 L_ffn_h_done
    s_mov_b64 exec, 0xffff
L_he_poll:
    global_load_dword v5, v34, s[30:31] sc1
    s_sub_u32 s35, s35, 1
    s_cbranch_scc1 L_end
    s_waitcnt vmcnt(0)
    v_cmp_ne_u32 vcc, s6, v5
    s_cbranch_vccnz L_he_poll
    s_mov_b64 exec, -1
L_e_poll:
    global_load_dwordx4 v[40:43], v25, s[30:31] sc1
    global_load_dwordx4 v[44:47], v33, s[30:31] sc1
    s_sub_u32 s35, s35, 1
    s_cbranch_scc1 L_end
    s_waitcnt vmcnt(0)
    v_max_u32 v35, v40, v44
    v_cmp_eq_u32 vcc, -1, v35
    s_cbranch_vccnz L_e_poll
    v_mfma_f32_16x16x32_bf16 v[56:59], v[16:19], v[40:43], v[56:59]
    v_mfma_f32_16x16x32_bf16 v[56:59], v[16:19], v[44:47], v[56:59]
    s_mov_b32 exec_lo, s38
    s_mov_b32 exec_hi, 0
    s_nop 5
    v_cvt_pk_bf16_f32 v56, v56, v57
    v_cvt_pk_bf16_f32 v57, v58, v59
    ds_write_b64 v26, v[56:57]
    s_mov_b64 exec, -1
L_ffn_h_done:
    s_waitcnt lgkmcnt(0)
    s_barrier
    s_cmp_lt_u32 s3, 4
    s_cbranch_scc1 L_ffn1
    s_cmp_eq_u32 s3, 5
    s_cbranch_scc1 L_ffn_stats
    s_cmp_eq_u32 s3, 7
    s_cbranch_scc0 L_no_hf
    s_mov_b64 exec, 1
    global_store_dword v36, v37, s[30:31] sc1
    s_mov_b64 exec, -1
L_no_hf:
    ds_read2_b32 v[50:51], v31 offset0:64 offset1:96
    s_branch L_ffn_u_done
L_ffn_stats:
    s_setprio 3
    ds_read_b128 v[40:43], v28
    ds_read_b32 v44, v29
    ds_read2_b32 v[50:51], v31 offset0:64 offset1:96
    s_waitcnt lgkmcnt(2)
    v_dot2_f32_bf16 v46, v40, s37, 0
    v_dot2_f32_bf16 v47, v40, v40, 0
    v_dot2_f32_bf16 v46, v41, s37, v46
    v_dot2_f32_bf16 v47, v41, v41, v47
    v_dot2_f32_bf16 v46, v42, s37, v46
    v_dot2_f32_bf16 v47, v42, v42, v47
    v_dot2_f32_bf16 v46, v43, s37, v46
    v_dot2_f32_bf16 v47, v43, v43, v47
    s_waitcnt lgkmcnt(1)
    v_dot2_f32_bf16 v46, v44, s37, v46
    v_dot2_f32_bf16 v47, v44, v44, v47
    s_nop 1
    v_add_f32_dpp v46, v46, v46 quad_perm:[1,0,3,2] row_mask:0xf bank_mask:0xf
    v_add_f32_dpp v47, v47, v47 quad_perm:[1,0,3,2] row_mask:0xf bank_mask:0xf
    s_nop 0
    v_add_f32_dpp v46, v46, v46 quad_perm:[2,3,0,1] row_mask:0xf bank_mask:0xf
    v_add_f32_dpp v47, v47, v47 quad_perm:[2,3,0,1] row_mask:0xf bank_mask:0xf
    s_nop 0
    v_add_f32_dpp v46, v46, v46 row_half_mirror row_mask:0xf bank_mask:0xf
    v_add_f32_dpp v47, v47, v47 row_half_mirror row_mask:0xf bank_mask:0xf
    s_nop 0
    v_add_f32_dpp v46, v46, v46 row_mirror row_mask:0xf bank_mask:0xf
    v_add_f32_dpp v47, v47, v47 row_mirror row_mask:0xf bank_mask:0xf
    s_nop 0
    v_add_f32_dpp v46, v46, v46 row_bcast:15 row_mask:0xa bank_mask:0xf
    v_add_f32_dpp v47, v47, v47 row_bcast:15 row_mask:0xa bank_mask:0xf
    s_nop 0
    v_add_f32_dpp v46, v46, v46 row_bcast:31 row_mask:0xc bank_mask:0xf
    v_add_f32_dpp v47, v47, v47 row_bcast:31 row_mask:0xc bank_mask:0xf
    v_mul_f32 v46, 0x3ae38e39, v46
    v_mul_f32 v47, 0x3ae38e39, v47
    v_fma_f32 v47, -v46, v46, v47
    v_max_f32 v47, 0, v47
    v_add_f32 v47, 0x3727c5ac, v47
    v_rsq_f32 v47, v47
    s_mov_b32 exec_lo, 0
    s_mov_b32 exec_hi, 0x80000000
    ds_write_b64 v22, v[46:47]
    s_mov_b64 exec, -1
    s_setprio 0
    s_branch L_ffn_u_done
L_ffn1:
    ds_read_b128 v[136:139], v27 offset:0
    ds_read_b128 v[140:143], v27 offset:64
    ds_read_b128 v[144:147], v27 offset:128
    ds_read_b128 v[148:151], v27 offset:192
    ds_read_b128 v[152:155], v27 offset:256
    ds_read_b128 v[156:159], v27 offset:320
    ds_read_b128 v[160:163], v27 offset:384
    ds_read_b128 v[164:167], v27 offset:448
    ds_read_b128 v[168:171], v27 offset:512
    ds_read2_b32 v[50:51], v31 offset0:64 offset1:96
    s_waitcnt lgkmcnt(9)
    v_mfma_f32_16x16x32_bf16 v[8:11], v[136:139], v[64:67], 0
    s_waitcnt lgkmcnt(8)
    v_mfma_f32_16x16x32_bf16 v[8:11], v[140:143], v[68:71], v[8:11]
    s_waitcnt lgkmcnt(7)
    v_mfma_f32_16x16x32_bf16 v[8:11], v[144:147], v[72:75], v[8:11]
    s_waitcnt lgkmcnt(6)
    v_mfma_f32_16x16x32_bf16 v[8:11], v[148:151], v[76:79], v[8:11]
    s_waitcnt lgkmcnt(5)
    v_mfma_f32_16x16x32_bf16 v[8:11], v[152:155], v[80:83], v[8:11]
    s_waitcnt lgkmcnt(4)
    v_mfma_f32_16x16x32_bf16 v[8:11], v[156:159], v[84:87], v[8:11]
    s_waitcnt lgkmcnt(3)
    v_mfma_f32_16x16x32_bf16 v[8:11], v[160:163], v[88:91], v[8:11]
    s_waitcnt lgkmcnt(2)
    v_mfma_f32_16x16x32_bf16 v[8:11], v[164:167], v[92:95], v[8:11]
    s_waitcnt lgkmcnt(1)
    v_mfma_f32_16x16x32_bf16 v[8:11], v[168:171], v[96:99], v[8:11]
    s_nop 7
    ds_write_b32 v30, v8
L_ffn_u_done:
    s_waitcnt lgkmcnt(0)
    s_barrier
    ds_read2_b32 v[8:9], v31 offset0:0 offset1:32
    ds_read_b64 v[46:47], v22
    v_add_f32 v50, v50, v51
    s_waitcnt lgkmcnt(0)
    v_add_f32 v8, v8, v9
    v_fma_f32 v8, -v46, v50, v8
    v_mul_f32 v8, v8, v47
    v_mul_f32 v9, 0xbfb8aa3b, v8
    v_exp_f32 v9, v9
    s_nop 0
    v_add_f32 v9, 1.0, v9
    v_rcp_f32 v9, v9
    s_nop 0
    v_mul_f32 v8, v8, v9
    s_nop 1
    v_mov_b32_dpp v9, v8 quad_perm:[1,1,3,3] row_mask:0xf bank_mask:0xf
    v_cvt_pk_bf16_f32 v40, v8, v9
    s_nop 1
    v_mov_b32_dpp v41, v40 row_shl:2 row_mask:0xf bank_mask:0xf
    v_mov_b32_dpp v42, v40 row_shl:4 row_mask:0xf bank_mask:0xf
    v_mov_b32_dpp v43, v40 row_shl:6 row_mask:0xf bank_mask:0xf
    s_nop 1
    v_mfma_f32_16x16x32_bf16 v[64:67], v[208:211], v[40:43], 0
    v_mfma_f32_16x16x32_bf16 v[68:71], v[212:215], v[40:43], 0
    v_mfma_f32_16x16x32_bf16 v[72:75], v[216:219], v[40:43], 0
    v_mfma_f32_16x16x32_bf16 v[76:79], v[220:223], v[40:43], 0
    s_cmp_lt_u32 s3, 2
    s_cbranch_scc1 L_ffn_three
    s_mov_b64 exec, s[40:41]
    s_nop 1
    v_cvt_pk_bf16_f32 v96, v64, v65
    v_cvt_pk_bf16_f32 v97, v66, v67
    v_cvt_pk_bf16_f32 v98, v68, v69
    v_cvt_pk_bf16_f32 v99, v70, v71
    global_store_dwordx4 v32, v[96:99], s[30:31] offset:0 sc1
    v_cvt_pk_bf16_f32 v100, v72, v73
    v_cvt_pk_bf16_f32 v101, v74, v75
    v_cvt_pk_bf16_f32 v102, v76, v77
    v_cvt_pk_bf16_f32 v103, v78, v79
    global_store_dwordx4 v32, v[100:103], s[30:31] offset:512 sc1
    s_branch L_end
L_ffn_three:
    v_mfma_f32_16x16x32_bf16 v[80:83], v[224:227], v[40:43], 0
    v_mfma_f32_16x16x32_bf16 v[84:87], v[228:231], v[40:43], 0
    s_mov_b64 exec, s[40:41]
    v_cvt_pk_bf16_f32 v96, v64, v65
    v_cvt_pk_bf16_f32 v97, v66, v67
    v_cvt_pk_bf16_f32 v98, v68, v69
    v_cvt_pk_bf16_f32 v99, v70, v71
    global_store_dwordx4 v32, v[96:99], s[30:31] offset:0 sc1
    v_cvt_pk_bf16_f32 v100, v72, v73
    v_cvt_pk_bf16_f32 v101, v74, v75
    v_cvt_pk_bf16_f32 v102, v76, v77
    v_cvt_pk_bf16_f32 v103, v78, v79
    global_store_dwordx4 v32, v[100:103], s[30:31] offset:512 sc1
    v_cvt_pk_bf16_f32 v104, v80, v81
    v_cvt_pk_bf16_f32 v105, v82, v83
    v_cvt_pk_bf16_f32 v106, v84, v85
    v_cvt_pk_bf16_f32 v107, v86, v87
    global_store_dwordx4 v32, v[104:107], s[30:31] offset:1024 sc1
L_end:
L_exit:
    s_endpgm
L_codeend:
.section .rodata,"a"
.p2align 6
.amdhsa_kernel sequential_preLN__compressed_kv_cla__dense_activation_silu__decode_kernel
  .amdhsa_next_free_vgpr 256
  .amdhsa_next_free_sgpr 96
  .amdhsa_accum_offset 256
  .amdhsa_group_segment_fixed_size 0
  .amdhsa_kernarg_size 96
  .amdhsa_user_sgpr_count 2
  .amdhsa_user_sgpr_kernarg_segment_ptr 1
  .amdhsa_system_sgpr_workgroup_id_x 1
.end_amdhsa_kernel
```
